```python
import torch

def _softmax(x, axis=-1):
    return torch.softmax(x, dim=axis)
def _gelu(x):
    return torch.nn.functional.gelu(x, approximate="tanh")
def _silu(x):
    return torch.nn.functional.silu(x)
def _sigmoid(x):
    return torch.sigmoid(x)
def _layernorm(x, axis=-1, eps=1e-5):
    m = x.mean(dim=axis, keepdim=True)
    v = x.var(dim=axis, keepdim=True, unbiased=False)
    return (x - m) / torch.sqrt(v + eps)
def _scatter_add(tgt, idx, src, axis=0):
    return tgt.clone().index_add_(axis, idx, src)
def _segment_sum(src, seg, n):
    out = torch.zeros((n,) + src.shape[1:], dtype=src.dtype)
    return out.index_add_(0, seg, src)
def _pad(x, pw):
    flat = tuple(v for pair in reversed(pw) for v in pair)
    return torch.nn.functional.pad(x, flat)

kernel_name = 'standalone__mha_softmax__near_ridge'

def setup_inputs():

    _w = (lambda a: (lambda t: t.to(torch.bfloat16) if t.is_floating_point() else t)(torch.as_tensor(a)))
    B, H, Sq, Sk, D = 8, 16, 368, 512, 256
    return {
        "q": _w((lambda *s: torch.randn(*s, dtype=torch.bfloat16) * 0.8)(B, H, Sq, D)),
        "k": _w((lambda *s: torch.randn(*s, dtype=torch.bfloat16) * 0.8)(B, H, Sk, D)),
        "v": _w((lambda *s: torch.randn(*s, dtype=torch.bfloat16) * 0.05)(B, H, Sk, D)),
    }

def reference(q, k, v):
    scale = q.shape[-1] ** -0.5
    scores = torch.einsum("bhqd,bhkd->bhqk", q, k) * scale
    p = _softmax(scores, axis=-1)
    return torch.einsum("bhqk,bhkd->bhqd", p, v)
```

```asm
; @launch grid=(256,1,1) block=(256,1,1) lds=163840
.amdgcn_target "amdgcn-amd-amdhsa--gfx950"
.text
.globl standalone__mha_softmax__near_ridge_kernel
.p2align 8
.type standalone__mha_softmax__near_ridge_kernel,@function
standalone__mha_softmax__near_ridge_kernel:
    s_cmp_ge_u32 s2, 256
    s_cbranch_scc1 L_exit
    s_load_dwordx8 s[52:59], s[0:1], 0
    v_lshrrev_b32_e32 v1, 6, v0
    s_mov_b32 s34, 0
    v_readfirstlane_b32 s31, v1
    s_getpc_b64 s[50:51]
L_pc:
    s_bfe_u32 s3, s2, 0x20003
    s_mul_i32 s3, s3, 9216
    v_mul_u32_u24_e32 v2, 9, v0
    v_lshrrev_b32_e32 v2, 5, v2
    v_lshl_add_u32 v2, v2, 7, s3
    v_min_u32_e32 v2, L_last-L_pc, v2
    global_load_dword v4, v2, s[50:51]
    v_mov_b32_e32 v248, 0x7f800000
    v_mov_b32_e32 v249, 0x7f800000
    v_mov_b32_e32 v250, 0x7f800000
L_start:
    v_mbcnt_lo_u32_b32 v8, -1, 0
    v_mbcnt_hi_u32_b32 v8, -1, v8
    s_lshr_b32 s36, s2, 4
    s_lshl_b32 s36, s36, 3
    s_and_b32 s3, s2, 7
    s_add_u32 s36, s36, s3
    s_bfe_u32 s3, s2, 0x10003
    s_lshl_b32 s3, s3, 2
    s_add_u32 s3, s3, s31
    s_cmp_eq_u32 s3, 7
    s_cselect_b32 s37, 0, -1
    s_cselect_b32 s40, 0xf149f2ca, -1
    s_mul_i32 s3, s3, 24576
    s_mul_i32 s38, s36, 188416
    s_add_u32 s38, s38, s3
    s_lshl_b32 s39, s36, 18
    s_lshl_b32 s32, s31, 12
    v_lshrrev_b32_e32 v9, 3, v8
    v_and_b32_e32 v10, 7, v8
    v_lshrrev_b32_e32 v11, 1, v9
    v_xor_b32_e32 v12, v10, v11
    v_lshlrev_b32_e32 v12, 4, v12
    v_lshl_add_u32 v12, v9, 9, v12
    v_xor_b32_e32 v13, 0x1040, v12
    s_and_b32 s3, s31, 1
    s_lshl_b32 s3, s3, 6
    s_or_b32 s3, s3, s32
    v_xor_b32_e32 v242, s3, v12
    s_lshl_b32 s35, s31, 13
    s_add_u32 s35, s35, 0x10000
    s_mov_b32 s24, 4096
    s_mov_b32 s25, 3200
    s_mov_b32 s26, 2304
    s_mov_b32 s27, 1408
    s_mov_b32 s10, 20480
    s_mov_b32 s11, 0x20000
    s_mov_b32 s6, 12288
    s_mov_b32 s7, 0x20000
    s_mov_b32 m0, s32
    s_waitcnt lgkmcnt(0)
    s_add_u32 s8, s54, s39
    s_addc_u32 s9, s55, 0
    s_sub_u32 s8, s8, 4096
    s_subb_u32 s9, s9, 0
    s_add_u32 s4, s52, s38
    s_addc_u32 s5, s53, 0
    s_sub_u32 s4, s4, 4096
    s_subb_u32 s5, s5, 0
    s_mov_b32 m0, s32
    s_nop 0
    buffer_load_dwordx4 v242, s[8:11], s24 offen offset:0 nt lds
    buffer_load_dwordx4 v242, s[8:11], s25 offen offset:1024 nt lds
    buffer_load_dwordx4 v242, s[8:11], s26 offen offset:2048 nt lds
    buffer_load_dwordx4 v242, s[8:11], s27 offen offset:3072 nt lds
    s_add_u32 m0, s32, 16384
    s_add_u32 s8, s8, 0x4000
    s_addc_u32 s9, s9, 0
    buffer_load_dwordx4 v242, s[8:11], s24 offen offset:0 nt lds
    buffer_load_dwordx4 v242, s[8:11], s25 offen offset:1024 nt lds
    buffer_load_dwordx4 v242, s[8:11], s26 offen offset:2048 nt lds
    buffer_load_dwordx4 v242, s[8:11], s27 offen offset:3072 nt lds
    s_add_u32 m0, s35, 0
    s_nop 0
    buffer_load_dwordx4 v12, s[4:7], s24 offen offset:0 nt lds
    s_add_u32 m0, s35, 4096
    s_nop 0
    buffer_load_dwordx4 v13, s[4:7], s24 offen offset:0 nt lds
    s_add_u32 s12, s56, s39
    s_addc_u32 s13, s57, 0
    s_mov_b32 s14, 65152
    s_mov_b32 s15, 0x20000
    s_add_u32 s16, s58, s38
    s_addc_u32 s17, s59, 0
    s_mov_b32 s18, 16384
    s_mov_b32 s19, 0x20000
    s_add_u32 s20, s16, 16384
    s_addc_u32 s21, s17, 0
    s_and_b32 s22, s37, 8192
    s_mov_b32 s23, 0x20000
    s_mov_b32 s64, s12
    s_mov_b32 s65, s13
    s_mov_b32 s66, 262144
    s_mov_b32 s67, 0x20000
    s_bfe_u32 s3, s2, 0x10003
    s_lshl_b32 s3, s3, 2
    s_add_u32 s3, s3, s31
    s_lshl_b32 s3, s3, 15
    s_lshr_b32 s3, s3, 2
    v_lshrrev_b32_e32 v14, 3, v8
    v_lshl_add_u32 v14, v14, 9, s3
    v_and_b32_e32 v15, 3, v8
    v_lshl_add_u32 v14, v15, 2, v14
    v_accvgpr_write_b32 a251, v14
    s_mov_b32 s28, 3072
    s_mov_b32 s29, 6144
    s_mov_b32 s30, 9216
    s_mov_b32 s44, 4096
    s_mov_b32 s45, 8192
    s_mov_b32 s46, 12288
    s_mov_b32 s33, 1035512379
    s_mov_b32 s47, 1317011456
    v_lshlrev_b32_e32 v14, 1, v11
    v_xor_b32_e32 v14, v14, v10
    v_lshlrev_b32_e32 v14, 4, v14
    v_lshl_add_u32 v14, v9, 9, v14
    s_lshl_b32 s3, s31, 14
    v_add_u32_e32 v243, s3, v14
    v_and_b32_e32 v16, 15, v8
    v_lshlrev_b32_e32 v16, 9, v16
    v_bfe_u32 v15, v8, 4, 1
    v_lshl_add_u32 v16, v15, 5, v16
    v_lshrrev_b32_e32 v15, 5, v8
    v_lshl_add_u32 v247, v15, 4, v16
    v_bfe_u32 v14, v8, 2, 3
    v_lshlrev_b32_e32 v18, 10, v15
    v_lshl_add_u32 v18, v14, 7, v18
    v_lshrrev_b32_e32 v14, 1, v14
    v_lshl_add_u32 v18, v14, 5, v18
    v_and_b32_e32 v14, 3, v8
    v_lshl_add_u32 v244, v14, 3, v18
    v_add_u32_e32 v244, 98304, v244
    v_bfe_u32 v14, v8, 3, 1
    v_lshlrev_b32_e32 v18, 12, v14
    v_lshl_add_u32 v18, v10, 7, v18
    v_bfe_u32 v14, v8, 1, 3
    v_lshrrev_b32_e32 v19, 4, v8
    v_xor_b32_e32 v14, v14, v19
    v_lshl_add_u32 v240, v14, 4, v18
    v_xor_b32_e32 v241, 64, v240
    v_add_u32_e32 v20, s35, v240
    v_add_u32_e32 v21, s35, v241
    v_mov_b32_e32 v22, s33
    v_min_f32_e32 v250, s40, v250
    v_mov_b32_e32 v14, 0x3f803f80
    v_accvgpr_write_b32 a172, v14
    v_accvgpr_write_b32 a173, v14
    v_accvgpr_write_b32 a174, v14
    v_accvgpr_write_b32 a175, v14
    v_and_b32_e32 v14, 1, v8
    v_mul_u32_u24_e32 v14, 0xaaaa, v14
    v_or_b32_e32 v14, 0x4444, v14
    v_lshl_or_b32 v253, v14, 16, v14
    v_accvgpr_write_b32 a160, 0
    v_accvgpr_write_b32 a161, 0
    v_accvgpr_write_b32 a162, 0
    v_accvgpr_write_b32 a163, 0
    v_accvgpr_write_b32 a164, 0
    v_accvgpr_write_b32 a165, 0
    v_accvgpr_write_b32 a166, 0
    v_accvgpr_write_b32 a167, 0
    v_accvgpr_write_b32 a168, 0
    v_accvgpr_write_b32 a169, 0
    v_accvgpr_write_b32 a170, 0
    v_accvgpr_write_b32 a171, 0
    s_mov_b64 vcc, -1
    s_cmp_eq_u32 s31, 0
    s_cbranch_scc1 L_walk0
    s_cmp_eq_u32 s31, 1
    s_cbranch_scc1 L_walk1
    s_cmp_eq_u32 s31, 2
    s_cbranch_scc1 L_walk2
    s_branch L_walk3
L_back:
    s_mov_b64 vcc, 0
    s_waitcnt vmcnt(6)
    s_add_u32 m0, s35, 4096
    s_nop 0
    buffer_load_dwordx4 v13, s[4:7], s25 offen offset:1024 nt lds
    s_add_u32 m0, s35, 0
    s_nop 0
    buffer_load_dwordx4 v12, s[4:7], s25 offen offset:1024 nt lds
    s_add_u32 m0, s35, 0
    s_nop 0
    buffer_load_dwordx4 v12, s[4:7], s26 offen offset:2048 nt lds
    s_add_u32 m0, s35, 4096
    s_nop 0
    buffer_load_dwordx4 v13, s[4:7], s26 offen offset:2048 nt lds
    s_barrier
    ds_read_b128 a[176:179], v240 offset:0
    ds_read_b128 a[208:211], v240 offset:8192
    ds_read_b128 a[180:183], v241 offset:0
    ds_read_b128 a[212:215], v241 offset:8192
    ds_read_b128 a[184:187], v240 offset:1024
    ds_read_b128 a[216:219], v240 offset:9216
    ds_read_b128 a[188:191], v241 offset:1024
    ds_read_b128 a[220:223], v241 offset:9216
    ds_read_b128 a[192:195], v240 offset:2048
    ds_read_b128 a[224:227], v240 offset:10240
    ds_read_b128 a[196:199], v241 offset:2048
    ds_read_b128 a[228:231], v241 offset:10240
    ds_read_b128 a[200:203], v240 offset:3072
    ds_read_b128 a[232:235], v240 offset:11264
    ds_read_b128 a[204:207], v241 offset:3072
    ds_read_b128 a[236:239], v241 offset:11264
    s_waitcnt vmcnt(6)
    s_add_u32 m0, s35, 4096
    s_nop 0
    buffer_load_dwordx4 v13, s[4:7], s27 offen offset:3072 nt lds
    s_add_u32 m0, s35, 0
    s_nop 0
    buffer_load_dwordx4 v12, s[4:7], s27 offen offset:3072 nt lds
    s_add_u32 m0, s35, 32768
    s_add_u32 s4, s4, 8192
    s_addc_u32 s5, s5, 0
    buffer_load_dwordx4 v12, s[4:7], s24 offen offset:0 nt lds
    s_add_u32 m0, s35, 36864
    s_nop 0
    buffer_load_dwordx4 v13, s[4:7], s24 offen offset:0 nt lds
    s_barrier
    ds_read_b128 v[128:131], v240 offset:16384
    ds_read_b128 v[160:163], v240 offset:24576
    ds_read_b128 v[132:135], v241 offset:16384
    ds_read_b128 v[164:167], v241 offset:24576
    ds_read_b128 v[136:139], v240 offset:17408
    ds_read_b128 v[168:171], v240 offset:25600
    ds_read_b128 v[140:143], v241 offset:17408
    ds_read_b128 v[172:175], v241 offset:25600
    ds_read_b128 v[144:147], v240 offset:18432
    ds_read_b128 v[176:179], v240 offset:26624
    ds_read_b128 v[148:151], v241 offset:18432
    ds_read_b128 v[180:183], v241 offset:26624
    ds_read_b128 v[152:155], v240 offset:19456
    ds_read_b128 v[184:187], v240 offset:27648
    ds_read_b128 v[156:159], v241 offset:19456
    ds_read_b128 v[188:191], v241 offset:27648
    s_waitcnt vmcnt(8)
    ds_read_b128 v[24:27], v20 offset:0
    ds_read_b128 v[28:31], v21 offset:0
    buffer_load_dwordx4 v13, s[4:7], s25 offen offset:1024 nt lds
    s_waitcnt lgkmcnt(0)
    v_lshlrev_b32_e32 v80, 16, v24
    v_and_b32_e32 v81, 0xffff0000, v24
    v_lshlrev_b32_e32 v82, 16, v25
    v_and_b32_e32 v83, 0xffff0000, v25
    v_lshlrev_b32_e32 v84, 16, v26
    v_and_b32_e32 v85, 0xffff0000, v26
    v_lshlrev_b32_e32 v86, 16, v27
    v_and_b32_e32 v87, 0xffff0000, v27
    v_lshlrev_b32_e32 v88, 16, v28
    v_and_b32_e32 v89, 0xffff0000, v28
    v_lshlrev_b32_e32 v90, 16, v29
    v_and_b32_e32 v91, 0xffff0000, v29
    v_lshlrev_b32_e32 v92, 16, v30
    v_and_b32_e32 v93, 0xffff0000, v30
    v_lshlrev_b32_e32 v94, 16, v31
    v_and_b32_e32 v95, 0xffff0000, v31
    v_pk_mul_f32 v[80:81], v[80:81], v[22:23] op_sel_hi:[1,0]
    v_pk_mul_f32 v[82:83], v[82:83], v[22:23] op_sel_hi:[1,0]
    v_pk_mul_f32 v[84:85], v[84:85], v[22:23] op_sel_hi:[1,0]
    v_pk_mul_f32 v[86:87], v[86:87], v[22:23] op_sel_hi:[1,0]
    v_pk_mul_f32 v[88:89], v[88:89], v[22:23] op_sel_hi:[1,0]
    v_pk_mul_f32 v[90:91], v[90:91], v[22:23] op_sel_hi:[1,0]
    v_pk_mul_f32 v[92:93], v[92:93], v[22:23] op_sel_hi:[1,0]
    v_pk_mul_f32 v[94:95], v[94:95], v[22:23] op_sel_hi:[1,0]
    s_waitcnt vmcnt(7)
    ds_read_b128 v[24:27], v20 offset:1024
    ds_read_b128 v[28:31], v21 offset:1024
    s_add_u32 m0, s35, 32768
    s_nop 0
    buffer_load_dwordx4 v12, s[4:7], s25 offen offset:1024 nt lds
    v_cvt_pk_bf16_f32 v80, v80, v81
    v_cvt_pk_bf16_f32 v82, v82, v83
    v_cvt_pk_bf16_f32 v84, v84, v85
    v_cvt_pk_bf16_f32 v86, v86, v87
    v_cvt_pk_bf16_f32 v88, v88, v89
    v_cvt_pk_bf16_f32 v90, v90, v91
    v_cvt_pk_bf16_f32 v92, v92, v93
    v_cvt_pk_bf16_f32 v94, v94, v95
    v_accvgpr_write_b32 a0, v80
    v_accvgpr_write_b32 a1, v82
    v_accvgpr_write_b32 a2, v84
    v_accvgpr_write_b32 a3, v86
    v_accvgpr_write_b32 a4, v88
    v_accvgpr_write_b32 a5, v90
    v_accvgpr_write_b32 a6, v92
    v_accvgpr_write_b32 a7, v94
    s_nop 0
    s_waitcnt lgkmcnt(0)
    v_mfma_f32_16x16x32_bf16 v[96:99], a[176:179], a[0:3], 0
    v_lshlrev_b32_e32 v80, 16, v24
    v_and_b32_e32 v81, 0xffff0000, v24
    v_mfma_f32_16x16x32_bf16 v[96:99], a[180:183], a[4:7], v[96:99]
    v_lshlrev_b32_e32 v82, 16, v25
    v_and_b32_e32 v83, 0xffff0000, v25
    v_mfma_f32_16x16x32_bf16 v[100:103], a[208:211], a[0:3], 0
    v_lshlrev_b32_e32 v84, 16, v26
    v_and_b32_e32 v85, 0xffff0000, v26
    v_mfma_f32_16x16x32_bf16 v[100:103], a[212:215], a[4:7], v[100:103]
    v_lshlrev_b32_e32 v86, 16, v27
    v_and_b32_e32 v87, 0xffff0000, v27
    v_mfma_f32_16x16x32_bf16 v[104:107], v[128:131], a[0:3], 0
    v_lshlrev_b32_e32 v88, 16, v28
    v_and_b32_e32 v89, 0xffff0000, v28
    v_mfma_f32_16x16x32_bf16 v[104:107], v[132:135], a[4:7], v[104:107]
    v_lshlrev_b32_e32 v90, 16, v29
    v_and_b32_e32 v91, 0xffff0000, v29
    v_mfma_f32_16x16x32_bf16 v[108:111], v[160:163], a[0:3], 0
    v_lshlrev_b32_e32 v92, 16, v30
    v_and_b32_e32 v93, 0xffff0000, v30
    v_mfma_f32_16x16x32_bf16 v[108:111], v[164:167], a[4:7], v[108:111]
    v_lshlrev_b32_e32 v94, 16, v31
    v_and_b32_e32 v95, 0xffff0000, v31
    v_pk_mul_f32 v[80:81], v[80:81], v[22:23] op_sel_hi:[1,0]
    v_pk_mul_f32 v[82:83], v[82:83], v[22:23] op_sel_hi:[1,0]
    v_pk_mul_f32 v[84:85], v[84:85], v[22:23] op_sel_hi:[1,0]
    v_pk_mul_f32 v[86:87], v[86:87], v[22:23] op_sel_hi:[1,0]
    v_pk_mul_f32 v[88:89], v[88:89], v[22:23] op_sel_hi:[1,0]
    v_pk_mul_f32 v[90:91], v[90:91], v[22:23] op_sel_hi:[1,0]
    v_pk_mul_f32 v[92:93], v[92:93], v[22:23] op_sel_hi:[1,0]
    v_pk_mul_f32 v[94:95], v[94:95], v[22:23] op_sel_hi:[1,0]
    s_waitcnt vmcnt(6)
    ds_read_b128 v[24:27], v20 offset:2048
    ds_read_b128 v[28:31], v21 offset:2048
    buffer_load_dwordx4 v12, s[4:7], s26 offen offset:2048 nt lds
    s_add_u32 m0, s35, 36864
    s_nop 0
    buffer_load_dwordx4 v13, s[4:7], s26 offen offset:2048 nt lds
    v_cvt_pk_bf16_f32 v80, v80, v81
    v_cvt_pk_bf16_f32 v82, v82, v83
    v_cvt_pk_bf16_f32 v84, v84, v85
    v_cvt_pk_bf16_f32 v86, v86, v87
    v_cvt_pk_bf16_f32 v88, v88, v89
    v_cvt_pk_bf16_f32 v90, v90, v91
    v_cvt_pk_bf16_f32 v92, v92, v93
    v_cvt_pk_bf16_f32 v94, v94, v95
    v_accvgpr_write_b32 a8, v80
    v_accvgpr_write_b32 a9, v82
    v_accvgpr_write_b32 a10, v84
    v_accvgpr_write_b32 a11, v86
    v_accvgpr_write_b32 a12, v88
    v_accvgpr_write_b32 a13, v90
    v_accvgpr_write_b32 a14, v92
    v_accvgpr_write_b32 a15, v94
    s_nop 0
    s_waitcnt lgkmcnt(0)
    v_mfma_f32_16x16x32_bf16 v[96:99], a[184:187], a[8:11], v[96:99]
    v_lshlrev_b32_e32 v80, 16, v24
    v_and_b32_e32 v81, 0xffff0000, v24
    v_mfma_f32_16x16x32_bf16 v[96:99], a[188:191], a[12:15], v[96:99]
    v_lshlrev_b32_e32 v82, 16, v25
    v_and_b32_e32 v83, 0xffff0000, v25
    v_mfma_f32_16x16x32_bf16 v[100:103], a[216:219], a[8:11], v[100:103]
    v_lshlrev_b32_e32 v84, 16, v26
    v_and_b32_e32 v85, 0xffff0000, v26
    v_mfma_f32_16x16x32_bf16 v[100:103], a[220:223], a[12:15], v[100:103]
    v_lshlrev_b32_e32 v86, 16, v27
    v_and_b32_e32 v87, 0xffff0000, v27
    v_mfma_f32_16x16x32_bf16 v[104:107], v[136:139], a[8:11], v[104:107]
    v_lshlrev_b32_e32 v88, 16, v28
    v_and_b32_e32 v89, 0xffff0000, v28
    v_mfma_f32_16x16x32_bf16 v[104:107], v[140:143], a[12:15], v[104:107]
    v_lshlrev_b32_e32 v90, 16, v29
    v_and_b32_e32 v91, 0xffff0000, v29
    v_mfma_f32_16x16x32_bf16 v[108:111], v[168:171], a[8:11], v[108:111]
    v_lshlrev_b32_e32 v92, 16, v30
    v_and_b32_e32 v93, 0xffff0000, v30
    v_mfma_f32_16x16x32_bf16 v[108:111], v[172:175], a[12:15], v[108:111]
    v_lshlrev_b32_e32 v94, 16, v31
    v_and_b32_e32 v95, 0xffff0000, v31
    v_pk_mul_f32 v[80:81], v[80:81], v[22:23] op_sel_hi:[1,0]
    v_pk_mul_f32 v[82:83], v[82:83], v[22:23] op_sel_hi:[1,0]
    v_pk_mul_f32 v[84:85], v[84:85], v[22:23] op_sel_hi:[1,0]
    v_pk_mul_f32 v[86:87], v[86:87], v[22:23] op_sel_hi:[1,0]
    v_pk_mul_f32 v[88:89], v[88:89], v[22:23] op_sel_hi:[1,0]
    v_pk_mul_f32 v[90:91], v[90:91], v[22:23] op_sel_hi:[1,0]
    v_pk_mul_f32 v[92:93], v[92:93], v[22:23] op_sel_hi:[1,0]
    v_pk_mul_f32 v[94:95], v[94:95], v[22:23] op_sel_hi:[1,0]
    s_waitcnt vmcnt(6)
    ds_read_b128 v[24:27], v20 offset:3072
    ds_read_b128 v[28:31], v21 offset:3072
    buffer_load_dwordx4 v13, s[4:7], s27 offen offset:3072 nt lds
    s_add_u32 m0, s35, 32768
    s_nop 0
    buffer_load_dwordx4 v12, s[4:7], s27 offen offset:3072 nt lds
    v_add_u32_e32 v20, 0x8000, v20
    v_add_u32_e32 v21, 0x8000, v21
    v_cvt_pk_bf16_f32 v80, v80, v81
    v_cvt_pk_bf16_f32 v82, v82, v83
    v_cvt_pk_bf16_f32 v84, v84, v85
    v_cvt_pk_bf16_f32 v86, v86, v87
    v_cvt_pk_bf16_f32 v88, v88, v89
    v_cvt_pk_bf16_f32 v90, v90, v91
    v_cvt_pk_bf16_f32 v92, v92, v93
    v_cvt_pk_bf16_f32 v94, v94, v95
    v_accvgpr_write_b32 a16, v80
    v_accvgpr_write_b32 a17, v82
    v_accvgpr_write_b32 a18, v84
    v_accvgpr_write_b32 a19, v86
    v_accvgpr_write_b32 a20, v88
    v_accvgpr_write_b32 a21, v90
    v_accvgpr_write_b32 a22, v92
    v_accvgpr_write_b32 a23, v94
    s_nop 0
    s_waitcnt lgkmcnt(0)
    v_mfma_f32_16x16x32_bf16 v[96:99], a[192:195], a[16:19], v[96:99]
    v_lshlrev_b32_e32 v80, 16, v24
    v_and_b32_e32 v81, 0xffff0000, v24
    v_mfma_f32_16x16x32_bf16 v[96:99], a[196:199], a[20:23], v[96:99]
    v_lshlrev_b32_e32 v82, 16, v25
    v_and_b32_e32 v83, 0xffff0000, v25
    v_mfma_f32_16x16x32_bf16 v[100:103], a[224:227], a[16:19], v[100:103]
    v_lshlrev_b32_e32 v84, 16, v26
    v_and_b32_e32 v85, 0xffff0000, v26
    v_mfma_f32_16x16x32_bf16 v[100:103], a[228:231], a[20:23], v[100:103]
    v_lshlrev_b32_e32 v86, 16, v27
    v_and_b32_e32 v87, 0xffff0000, v27
    v_mfma_f32_16x16x32_bf16 v[104:107], v[144:147], a[16:19], v[104:107]
    v_lshlrev_b32_e32 v88, 16, v28
    v_and_b32_e32 v89, 0xffff0000, v28
    v_mfma_f32_16x16x32_bf16 v[104:107], v[148:151], a[20:23], v[104:107]
    v_lshlrev_b32_e32 v90, 16, v29
    v_and_b32_e32 v91, 0xffff0000, v29
    v_mfma_f32_16x16x32_bf16 v[108:111], v[176:179], a[16:19], v[108:111]
    v_lshlrev_b32_e32 v92, 16, v30
    v_and_b32_e32 v93, 0xffff0000, v30
    v_mfma_f32_16x16x32_bf16 v[108:111], v[180:183], a[20:23], v[108:111]
    v_lshlrev_b32_e32 v94, 16, v31
    v_and_b32_e32 v95, 0xffff0000, v31
    v_pk_mul_f32 v[80:81], v[80:81], v[22:23] op_sel_hi:[1,0]
    v_pk_mul_f32 v[82:83], v[82:83], v[22:23] op_sel_hi:[1,0]
    v_pk_mul_f32 v[84:85], v[84:85], v[22:23] op_sel_hi:[1,0]
    v_pk_mul_f32 v[86:87], v[86:87], v[22:23] op_sel_hi:[1,0]
    v_pk_mul_f32 v[88:89], v[88:89], v[22:23] op_sel_hi:[1,0]
    v_pk_mul_f32 v[90:91], v[90:91], v[22:23] op_sel_hi:[1,0]
    v_pk_mul_f32 v[92:93], v[92:93], v[22:23] op_sel_hi:[1,0]
    v_pk_mul_f32 v[94:95], v[94:95], v[22:23] op_sel_hi:[1,0]
    s_waitcnt vmcnt(6)
    ds_read_b128 v[24:27], v20 offset:0
    ds_read_b128 v[28:31], v21 offset:0
    s_add_u32 m0, s35, 65536
    s_add_u32 s4, s4, 8192
    s_addc_u32 s5, s5, 0
    s_and_b32 s6, s6, s37
    buffer_load_dwordx4 v12, s[4:7], s24 offen offset:0 nt lds
    s_add_u32 m0, s35, 69632
    s_nop 0
    buffer_load_dwordx4 v13, s[4:7], s24 offen offset:0 nt lds
    v_cvt_pk_bf16_f32 v80, v80, v81
    v_cvt_pk_bf16_f32 v82, v82, v83
    v_cvt_pk_bf16_f32 v84, v84, v85
    v_cvt_pk_bf16_f32 v86, v86, v87
    v_cvt_pk_bf16_f32 v88, v88, v89
    v_cvt_pk_bf16_f32 v90, v90, v91
    v_cvt_pk_bf16_f32 v92, v92, v93
    v_cvt_pk_bf16_f32 v94, v94, v95
    v_accvgpr_write_b32 a24, v80
    v_accvgpr_write_b32 a25, v82
    v_accvgpr_write_b32 a26, v84
    v_accvgpr_write_b32 a27, v86
    v_accvgpr_write_b32 a28, v88
    v_accvgpr_write_b32 a29, v90
    v_accvgpr_write_b32 a30, v92
    v_accvgpr_write_b32 a31, v94
    s_nop 0
    s_waitcnt lgkmcnt(0)
    v_mfma_f32_16x16x32_bf16 v[96:99], a[200:203], a[24:27], v[96:99]
    v_lshlrev_b32_e32 v80, 16, v24
    v_and_b32_e32 v81, 0xffff0000, v24
    v_mfma_f32_16x16x32_bf16 v[96:99], a[204:207], a[28:31], v[96:99]
    v_lshlrev_b32_e32 v82, 16, v25
    v_and_b32_e32 v83, 0xffff0000, v25
    v_mfma_f32_16x16x32_bf16 v[100:103], a[232:235], a[24:27], v[100:103]
    v_lshlrev_b32_e32 v84, 16, v26
    v_and_b32_e32 v85, 0xffff0000, v26
    v_mfma_f32_16x16x32_bf16 v[100:103], a[236:239], a[28:31], v[100:103]
    v_lshlrev_b32_e32 v86, 16, v27
    v_and_b32_e32 v87, 0xffff0000, v27
    v_mfma_f32_16x16x32_bf16 v[104:107], v[152:155], a[24:27], v[104:107]
    v_lshlrev_b32_e32 v88, 16, v28
    v_and_b32_e32 v89, 0xffff0000, v28
    v_mfma_f32_16x16x32_bf16 v[104:107], v[156:159], a[28:31], v[104:107]
    v_lshlrev_b32_e32 v90, 16, v29
    v_and_b32_e32 v91, 0xffff0000, v29
    v_mfma_f32_16x16x32_bf16 v[108:111], v[184:187], a[24:27], v[108:111]
    v_lshlrev_b32_e32 v92, 16, v30
    v_and_b32_e32 v93, 0xffff0000, v30
    v_mfma_f32_16x16x32_bf16 v[108:111], v[188:191], a[28:31], v[108:111]
    v_lshlrev_b32_e32 v94, 16, v31
    v_and_b32_e32 v95, 0xffff0000, v31
    v_pk_mul_f32 v[80:81], v[80:81], v[22:23] op_sel_hi:[1,0]
    v_pk_mul_f32 v[82:83], v[82:83], v[22:23] op_sel_hi:[1,0]
    v_pk_mul_f32 v[84:85], v[84:85], v[22:23] op_sel_hi:[1,0]
    v_pk_mul_f32 v[86:87], v[86:87], v[22:23] op_sel_hi:[1,0]
    v_pk_mul_f32 v[88:89], v[88:89], v[22:23] op_sel_hi:[1,0]
    v_pk_mul_f32 v[90:91], v[90:91], v[22:23] op_sel_hi:[1,0]
    v_pk_mul_f32 v[92:93], v[92:93], v[22:23] op_sel_hi:[1,0]
    v_pk_mul_f32 v[94:95], v[94:95], v[22:23] op_sel_hi:[1,0]
    v_max3_f32 v254, v96, v97, v98
    v_max3_f32 v255, v104, v105, v106
    v_max3_f32 v254, v254, v99, v100
    v_max3_f32 v255, v255, v107, v108
    v_max3_f32 v254, v254, v101, v102
    v_max3_f32 v255, v255, v109, v110
    v_max3_f32 v254, v254, v103, v111
    v_max_f32_e32 v254, v254, v255
    v_mov_b32_e32 v255, v254
    s_nop 1
    v_permlane32_swap_b32_e32 v254, v255
    v_max_f32_e32 v254, v254, v255
    v_mov_b32_e32 v255, v254
    s_nop 1
    v_permlane16_swap_b32_e32 v254, v255
    v_max_f32_e32 v254, v254, v255
    v_min_f32_e64 v248, v248, -v254
    v_mov_b32_e32 v192, v248
    v_mov_b32_e32 v193, v248
    v_mov_b32_e32 v194, v248
    v_mov_b32_e32 v195, v248
    v_add_f32_e32 v96, v96, v248
    v_add_f32_e32 v97, v97, v248
    v_add_f32_e32 v98, v98, v248
    v_add_f32_e32 v99, v99, v248
    v_add_f32_e32 v100, v100, v248
    v_add_f32_e32 v101, v101, v248
    v_add_f32_e32 v102, v102, v248
    v_add_f32_e32 v103, v103, v248
    v_add_f32_e32 v104, v104, v248
    v_add_f32_e32 v105, v105, v248
    v_add_f32_e32 v106, v106, v248
    v_add_f32_e32 v107, v107, v248
    v_add_f32_e32 v108, v108, v248
    v_add_f32_e32 v109, v109, v248
    v_add_f32_e32 v110, v110, v248
    v_add_f32_e32 v111, v111, v248
    v_exp_f32_e32 v96, v96
    v_exp_f32_e32 v97, v97
    v_exp_f32_e32 v98, v98
    v_exp_f32_e32 v99, v99
    v_exp_f32_e32 v100, v100
    v_exp_f32_e32 v101, v101
    v_exp_f32_e32 v102, v102
    v_exp_f32_e32 v103, v103
    v_exp_f32_e32 v104, v104
    v_exp_f32_e32 v105, v105
    v_exp_f32_e32 v106, v106
    v_exp_f32_e32 v107, v107
    v_exp_f32_e32 v108, v108
    v_exp_f32_e32 v109, v109
    v_exp_f32_e32 v110, v110
    v_exp_f32_e32 v111, v111
    v_cvt_pk_bf16_f32 v0, v96, v97
    v_cvt_pk_bf16_f32 v1, v98, v99
    v_cvt_pk_bf16_f32 v2, v100, v101
    v_cvt_pk_bf16_f32 v3, v102, v103
    v_cvt_pk_bf16_f32 v4, v104, v105
    v_cvt_pk_bf16_f32 v5, v106, v107
    v_cvt_pk_bf16_f32 v6, v108, v109
    v_cvt_pk_bf16_f32 v7, v110, v111
    s_nop 1
    v_smfmac_f32_16x16x64_bf16 a[160:163], a[172:175], v[0:7], v253
    s_waitcnt vmcnt(6)
    ds_read_b128 v[24:27], v20 offset:1024
    ds_read_b128 v[28:31], v21 offset:1024
    buffer_load_dwordx4 v13, s[4:7], s25 offen offset:1024 nt lds
    s_add_u32 m0, s35, 65536
    s_nop 0
    buffer_load_dwordx4 v12, s[4:7], s25 offen offset:1024 nt lds
    v_cvt_pk_bf16_f32 v80, v80, v81
    v_cvt_pk_bf16_f32 v82, v82, v83
    v_cvt_pk_bf16_f32 v84, v84, v85
    v_cvt_pk_bf16_f32 v86, v86, v87
    v_cvt_pk_bf16_f32 v88, v88, v89
    v_cvt_pk_bf16_f32 v90, v90, v91
    v_cvt_pk_bf16_f32 v92, v92, v93
    v_cvt_pk_bf16_f32 v94, v94, v95
    v_accvgpr_write_b32 a32, v80
    v_accvgpr_write_b32 a33, v82
    v_accvgpr_write_b32 a34, v84
    v_accvgpr_write_b32 a35, v86
    v_accvgpr_write_b32 a36, v88
    v_accvgpr_write_b32 a37, v90
    v_accvgpr_write_b32 a38, v92
    v_accvgpr_write_b32 a39, v94
    s_nop 0
    s_waitcnt lgkmcnt(0)
    v_mfma_f32_16x16x32_bf16 v[96:99], a[176:179], a[32:35], 0
    v_lshlrev_b32_e32 v80, 16, v24
    v_and_b32_e32 v81, 0xffff0000, v24
    v_mfma_f32_16x16x32_bf16 v[96:99], a[180:183], a[36:39], v[96:99]
    v_lshlrev_b32_e32 v82, 16, v25
    v_and_b32_e32 v83, 0xffff0000, v25
    v_mfma_f32_16x16x32_bf16 v[100:103], a[208:211], a[32:35], 0
    v_lshlrev_b32_e32 v84, 16, v26
    v_and_b32_e32 v85, 0xffff0000, v26
    v_mfma_f32_16x16x32_bf16 v[100:103], a[212:215], a[36:39], v[100:103]
    v_lshlrev_b32_e32 v86, 16, v27
    v_and_b32_e32 v87, 0xffff0000, v27
    v_mfma_f32_16x16x32_bf16 v[104:107], v[128:131], a[32:35], 0
    v_lshlrev_b32_e32 v88, 16, v28
    v_and_b32_e32 v89, 0xffff0000, v28
    v_mfma_f32_16x16x32_bf16 v[104:107], v[132:135], a[36:39], v[104:107]
    v_lshlrev_b32_e32 v90, 16, v29
    v_and_b32_e32 v91, 0xffff0000, v29
    v_mfma_f32_16x16x32_bf16 v[108:111], v[160:163], a[32:35], 0
    v_lshlrev_b32_e32 v92, 16, v30
    v_and_b32_e32 v93, 0xffff0000, v30
    v_mfma_f32_16x16x32_bf16 v[108:111], v[164:167], a[36:39], v[108:111]
    v_lshlrev_b32_e32 v94, 16, v31
    v_and_b32_e32 v95, 0xffff0000, v31
    v_pk_mul_f32 v[80:81], v[80:81], v[22:23] op_sel_hi:[1,0]
    v_pk_mul_f32 v[82:83], v[82:83], v[22:23] op_sel_hi:[1,0]
    v_pk_mul_f32 v[84:85], v[84:85], v[22:23] op_sel_hi:[1,0]
    v_pk_mul_f32 v[86:87], v[86:87], v[22:23] op_sel_hi:[1,0]
    v_pk_mul_f32 v[88:89], v[88:89], v[22:23] op_sel_hi:[1,0]
    v_pk_mul_f32 v[90:91], v[90:91], v[22:23] op_sel_hi:[1,0]
    v_pk_mul_f32 v[92:93], v[92:93], v[22:23] op_sel_hi:[1,0]
    v_pk_mul_f32 v[94:95], v[94:95], v[22:23] op_sel_hi:[1,0]
    s_waitcnt vmcnt(6)
    ds_read_b128 v[24:27], v20 offset:2048
    ds_read_b128 v[28:31], v21 offset:2048
    buffer_load_dwordx4 v12, s[4:7], s26 offen offset:2048 nt lds
    s_add_u32 m0, s35, 69632
    s_nop 0
    buffer_load_dwordx4 v13, s[4:7], s26 offen offset:2048 nt lds
    v_cvt_pk_bf16_f32 v80, v80, v81
    v_cvt_pk_bf16_f32 v82, v82, v83
    v_cvt_pk_bf16_f32 v84, v84, v85
    v_cvt_pk_bf16_f32 v86, v86, v87
    v_cvt_pk_bf16_f32 v88, v88, v89
    v_cvt_pk_bf16_f32 v90, v90, v91
    v_cvt_pk_bf16_f32 v92, v92, v93
    v_cvt_pk_bf16_f32 v94, v94, v95
    v_accvgpr_write_b32 a40, v80
    v_accvgpr_write_b32 a41, v82
    v_accvgpr_write_b32 a42, v84
    v_accvgpr_write_b32 a43, v86
    v_accvgpr_write_b32 a44, v88
    v_accvgpr_write_b32 a45, v90
    v_accvgpr_write_b32 a46, v92
    v_accvgpr_write_b32 a47, v94
    s_nop 0
    s_waitcnt lgkmcnt(0)
    v_mfma_f32_16x16x32_bf16 v[96:99], a[184:187], a[40:43], v[96:99]
    v_lshlrev_b32_e32 v80, 16, v24
    v_and_b32_e32 v81, 0xffff0000, v24
    v_mfma_f32_16x16x32_bf16 v[96:99], a[188:191], a[44:47], v[96:99]
    v_lshlrev_b32_e32 v82, 16, v25
    v_and_b32_e32 v83, 0xffff0000, v25
    v_mfma_f32_16x16x32_bf16 v[100:103], a[216:219], a[40:43], v[100:103]
    v_lshlrev_b32_e32 v84, 16, v26
    v_and_b32_e32 v85, 0xffff0000, v26
    v_mfma_f32_16x16x32_bf16 v[100:103], a[220:223], a[44:47], v[100:103]
    v_lshlrev_b32_e32 v86, 16, v27
    v_and_b32_e32 v87, 0xffff0000, v27
    v_mfma_f32_16x16x32_bf16 v[104:107], v[136:139], a[40:43], v[104:107]
    v_lshlrev_b32_e32 v88, 16, v28
    v_and_b32_e32 v89, 0xffff0000, v28
    v_mfma_f32_16x16x32_bf16 v[104:107], v[140:143], a[44:47], v[104:107]
    v_lshlrev_b32_e32 v90, 16, v29
    v_and_b32_e32 v91, 0xffff0000, v29
    v_mfma_f32_16x16x32_bf16 v[108:111], v[168:171], a[40:43], v[108:111]
    v_lshlrev_b32_e32 v92, 16, v30
    v_and_b32_e32 v93, 0xffff0000, v30
    v_mfma_f32_16x16x32_bf16 v[108:111], v[172:175], a[44:47], v[108:111]
    v_lshlrev_b32_e32 v94, 16, v31
    v_and_b32_e32 v95, 0xffff0000, v31
    v_pk_mul_f32 v[80:81], v[80:81], v[22:23] op_sel_hi:[1,0]
    v_pk_mul_f32 v[82:83], v[82:83], v[22:23] op_sel_hi:[1,0]
    v_pk_mul_f32 v[84:85], v[84:85], v[22:23] op_sel_hi:[1,0]
    v_pk_mul_f32 v[86:87], v[86:87], v[22:23] op_sel_hi:[1,0]
    v_pk_mul_f32 v[88:89], v[88:89], v[22:23] op_sel_hi:[1,0]
    v_pk_mul_f32 v[90:91], v[90:91], v[22:23] op_sel_hi:[1,0]
    v_pk_mul_f32 v[92:93], v[92:93], v[22:23] op_sel_hi:[1,0]
    v_pk_mul_f32 v[94:95], v[94:95], v[22:23] op_sel_hi:[1,0]
    s_waitcnt vmcnt(6)
    ds_read_b128 v[24:27], v20 offset:3072
    ds_read_b128 v[28:31], v21 offset:3072
    buffer_load_dwordx4 v13, s[4:7], s27 offen offset:3072 nt lds
    v_add_u32_e32 v20, 0x8000, v20
    v_add_u32_e32 v21, 0x8000, v21
    v_cvt_pk_bf16_f32 v80, v80, v81
    v_cvt_pk_bf16_f32 v82, v82, v83
    v_cvt_pk_bf16_f32 v84, v84, v85
    v_cvt_pk_bf16_f32 v86, v86, v87
    v_cvt_pk_bf16_f32 v88, v88, v89
    v_cvt_pk_bf16_f32 v90, v90, v91
    v_cvt_pk_bf16_f32 v92, v92, v93
    v_cvt_pk_bf16_f32 v94, v94, v95
    v_accvgpr_write_b32 a48, v80
    v_accvgpr_write_b32 a49, v82
    v_accvgpr_write_b32 a50, v84
    v_accvgpr_write_b32 a51, v86
    v_accvgpr_write_b32 a52, v88
    v_accvgpr_write_b32 a53, v90
L_walk0:
L_pad0:
    s_cbranch_vccnz L_pad1
    v_accvgpr_write_b32 a54, v92
    v_accvgpr_write_b32 a55, v94
    s_nop 0
    s_waitcnt lgkmcnt(0)
    v_mfma_f32_16x16x32_bf16 v[96:99], a[192:195], a[48:51], v[96:99]
    v_lshlrev_b32_e32 v80, 16, v24
    v_and_b32_e32 v81, 0xffff0000, v24
    v_mfma_f32_16x16x32_bf16 v[96:99], a[196:199], a[52:55], v[96:99]
    v_lshlrev_b32_e32 v82, 16, v25
    v_and_b32_e32 v83, 0xffff0000, v25
    v_mfma_f32_16x16x32_bf16 v[100:103], a[224:227], a[48:51], v[100:103]
    v_lshlrev_b32_e32 v84, 16, v26
    v_and_b32_e32 v85, 0xffff0000, v26
    v_mfma_f32_16x16x32_bf16 v[100:103], a[228:231], a[52:55], v[100:103]
    v_lshlrev_b32_e32 v86, 16, v27
    v_and_b32_e32 v87, 0xffff0000, v27
    v_mfma_f32_16x16x32_bf16 v[104:107], v[144:147], a[48:51], v[104:107]
    v_lshlrev_b32_e32 v88, 16, v28
    v_and_b32_e32 v89, 0xffff0000, v28
    v_mfma_f32_16x16x32_bf16 v[104:107], v[148:151], a[52:55], v[104:107]
    v_lshlrev_b32_e32 v90, 16, v29
    v_and_b32_e32 v91, 0xffff0000, v29
    v_mfma_f32_16x16x32_bf16 v[108:111], v[176:179], a[48:51], v[108:111]
    v_lshlrev_b32_e32 v92, 16, v30
    v_and_b32_e32 v93, 0xffff0000, v30
    v_mfma_f32_16x16x32_bf16 v[108:111], v[180:183], a[52:55], v[108:111]
    v_lshlrev_b32_e32 v94, 16, v31
    v_and_b32_e32 v95, 0xffff0000, v31
    v_pk_mul_f32 v[80:81], v[80:81], v[22:23] op_sel_hi:[1,0]
    v_pk_mul_f32 v[82:83], v[82:83], v[22:23] op_sel_hi:[1,0]
    v_pk_mul_f32 v[84:85], v[84:85], v[22:23] op_sel_hi:[1,0]
    v_pk_mul_f32 v[86:87], v[86:87], v[22:23] op_sel_hi:[1,0]
    v_pk_mul_f32 v[88:89], v[88:89], v[22:23] op_sel_hi:[1,0]
    v_pk_mul_f32 v[90:91], v[90:91], v[22:23] op_sel_hi:[1,0]
    v_pk_mul_f32 v[92:93], v[92:93], v[22:23] op_sel_hi:[1,0]
    v_pk_mul_f32 v[94:95], v[94:95], v[22:23] op_sel_hi:[1,0]
    s_waitcnt vmcnt(5)
    ds_read_b128 v[24:27], v20 offset:0
    ds_read_b128 v[28:31], v21 offset:0
    s_add_u32 m0, s35, 65536
    s_nop 0
    buffer_load_dwordx4 v12, s[4:7], s27 offen offset:3072 nt lds
    v_cvt_pk_bf16_f32 v80, v80, v81
    v_cvt_pk_bf16_f32 v82, v82, v83
    v_cvt_pk_bf16_f32 v84, v84, v85
    v_cvt_pk_bf16_f32 v86, v86, v87
    v_cvt_pk_bf16_f32 v88, v88, v89
    v_cvt_pk_bf16_f32 v90, v90, v91
    v_cvt_pk_bf16_f32 v92, v92, v93
    v_cvt_pk_bf16_f32 v94, v94, v95
    v_accvgpr_write_b32 a56, v80
    v_accvgpr_write_b32 a57, v82
    v_accvgpr_write_b32 a58, v84
    v_accvgpr_write_b32 a59, v86
    v_accvgpr_write_b32 a60, v88
    v_accvgpr_write_b32 a61, v90
    v_accvgpr_write_b32 a62, v92
    v_accvgpr_write_b32 a63, v94
    s_nop 0
    s_waitcnt lgkmcnt(0)
    v_mfma_f32_16x16x32_bf16 v[96:99], a[200:203], a[56:59], v[96:99]
    v_lshlrev_b32_e32 v80, 16, v24
    v_and_b32_e32 v81, 0xffff0000, v24
    v_mfma_f32_16x16x32_bf16 v[96:99], a[204:207], a[60:63], v[96:99]
    v_lshlrev_b32_e32 v82, 16, v25
    v_and_b32_e32 v83, 0xffff0000, v25
    v_mfma_f32_16x16x32_bf16 v[100:103], a[232:235], a[56:59], v[100:103]
    v_lshlrev_b32_e32 v84, 16, v26
    v_and_b32_e32 v85, 0xffff0000, v26
    v_mfma_f32_16x16x32_bf16 v[100:103], a[236:239], a[60:63], v[100:103]
    v_lshlrev_b32_e32 v86, 16, v27
    v_and_b32_e32 v87, 0xffff0000, v27
    v_mfma_f32_16x16x32_bf16 v[104:107], v[152:155], a[56:59], v[104:107]
    v_lshlrev_b32_e32 v88, 16, v28
    v_and_b32_e32 v89, 0xffff0000, v28
    v_mfma_f32_16x16x32_bf16 v[104:107], v[156:159], a[60:63], v[104:107]
    v_lshlrev_b32_e32 v90, 16, v29
    v_and_b32_e32 v91, 0xffff0000, v29
    v_mfma_f32_16x16x32_bf16 v[108:111], v[184:187], a[56:59], v[108:111]
    v_lshlrev_b32_e32 v92, 16, v30
    v_and_b32_e32 v93, 0xffff0000, v30
    v_mfma_f32_16x16x32_bf16 v[108:111], v[188:191], a[60:63], v[108:111]
    v_lshlrev_b32_e32 v94, 16, v31
    v_and_b32_e32 v95, 0xffff0000, v31
    v_pk_mul_f32 v[80:81], v[80:81], v[22:23] op_sel_hi:[1,0]
    v_pk_mul_f32 v[82:83], v[82:83], v[22:23] op_sel_hi:[1,0]
    v_pk_mul_f32 v[84:85], v[84:85], v[22:23] op_sel_hi:[1,0]
    v_pk_mul_f32 v[86:87], v[86:87], v[22:23] op_sel_hi:[1,0]
    v_pk_mul_f32 v[88:89], v[88:89], v[22:23] op_sel_hi:[1,0]
    v_pk_mul_f32 v[90:91], v[90:91], v[22:23] op_sel_hi:[1,0]
    v_pk_mul_f32 v[92:93], v[92:93], v[22:23] op_sel_hi:[1,0]
    v_pk_mul_f32 v[94:95], v[94:95], v[22:23] op_sel_hi:[1,0]
    v_max3_f32 v254, v96, v97, v98
    v_max3_f32 v255, v104, v105, v106
    v_max3_f32 v254, v254, v99, v100
    v_max3_f32 v255, v255, v107, v108
    v_max3_f32 v254, v254, v101, v102
    v_max3_f32 v255, v255, v109, v110
    v_max3_f32 v254, v254, v103, v111
    v_max_f32_e32 v254, v254, v255
    v_mov_b32_e32 v255, v254
    s_nop 1
    v_permlane32_swap_b32_e32 v254, v255
    v_max_f32_e32 v254, v254, v255
    v_mov_b32_e32 v255, v254
    s_nop 1
    v_permlane16_swap_b32_e32 v254, v255
    v_max_f32_e32 v254, v254, v255
    v_min_f32_e64 v249, v249, -v254
    v_mov_b32_e32 v196, v249
    v_mov_b32_e32 v197, v249
    v_mov_b32_e32 v198, v249
    v_mov_b32_e32 v199, v249
    v_add_f32_e32 v96, v96, v249
    v_add_f32_e32 v97, v97, v249
    v_add_f32_e32 v98, v98, v249
    v_add_f32_e32 v99, v99, v249
    v_add_f32_e32 v100, v100, v249
    v_add_f32_e32 v101, v101, v249
    v_add_f32_e32 v102, v102, v249
    v_add_f32_e32 v103, v103, v249
    v_add_f32_e32 v104, v104, v249
    v_add_f32_e32 v105, v105, v249
    v_add_f32_e32 v106, v106, v249
    v_add_f32_e32 v107, v107, v249
    v_add_f32_e32 v108, v108, v249
    v_add_f32_e32 v109, v109, v249
    v_add_f32_e32 v110, v110, v249
    v_add_f32_e32 v111, v111, v249
    v_exp_f32_e32 v96, v96
    v_exp_f32_e32 v97, v97
    v_exp_f32_e32 v98, v98
    v_exp_f32_e32 v99, v99
    v_exp_f32_e32 v100, v100
    v_exp_f32_e32 v101, v101
    v_exp_f32_e32 v102, v102
    v_exp_f32_e32 v103, v103
    v_exp_f32_e32 v104, v104
    v_exp_f32_e32 v105, v105
    v_exp_f32_e32 v106, v106
    v_exp_f32_e32 v107, v107
    v_exp_f32_e32 v108, v108
    v_exp_f32_e32 v109, v109
    v_exp_f32_e32 v110, v110
    v_exp_f32_e32 v111, v111
    v_cvt_pk_bf16_f32 v64, v96, v97
    v_cvt_pk_bf16_f32 v65, v98, v99
    v_cvt_pk_bf16_f32 v66, v100, v101
    v_cvt_pk_bf16_f32 v67, v102, v103
    v_cvt_pk_bf16_f32 v68, v104, v105
    v_cvt_pk_bf16_f32 v69, v106, v107
    v_cvt_pk_bf16_f32 v70, v108, v109
    v_cvt_pk_bf16_f32 v71, v110, v111
    s_nop 1
    v_smfmac_f32_16x16x64_bf16 a[164:167], a[172:175], v[64:71], v253
    s_waitcnt vmcnt(4)
    ds_read_b128 v[24:27], v20 offset:1024
    ds_read_b128 v[28:31], v21 offset:1024
    s_add_u32 m0, s32, 32768
    s_add_u32 s8, s8, 0x4000
    s_addc_u32 s9, s9, 0
    buffer_load_dwordx4 v242, s[8:11], s24 offen offset:0 nt lds
    buffer_load_dwordx4 v242, s[8:11], s25 offen offset:1024 nt lds
    v_cvt_pk_bf16_f32 v80, v80, v81
    v_cvt_pk_bf16_f32 v82, v82, v83
    v_cvt_pk_bf16_f32 v84, v84, v85
    v_cvt_pk_bf16_f32 v86, v86, v87
    v_cvt_pk_bf16_f32 v88, v88, v89
    v_cvt_pk_bf16_f32 v90, v90, v91
    v_cvt_pk_bf16_f32 v92, v92, v93
    v_cvt_pk_bf16_f32 v94, v94, v95
    v_accvgpr_write_b32 a64, v80
    v_accvgpr_write_b32 a65, v82
    v_accvgpr_write_b32 a66, v84
    v_accvgpr_write_b32 a67, v86
    v_accvgpr_write_b32 a68, v88
    v_accvgpr_write_b32 a69, v90
    v_accvgpr_write_b32 a70, v92
    v_accvgpr_write_b32 a71, v94
    s_nop 0
    s_waitcnt lgkmcnt(0)
    v_mfma_f32_16x16x32_bf16 v[96:99], a[176:179], a[64:67], 0
    v_lshlrev_b32_e32 v80, 16, v24
    v_and_b32_e32 v81, 0xffff0000, v24
    v_mfma_f32_16x16x32_bf16 v[96:99], a[180:183], a[68:71], v[96:99]
    v_lshlrev_b32_e32 v82, 16, v25
    v_and_b32_e32 v83, 0xffff0000, v25
    v_mfma_f32_16x16x32_bf16 v[100:103], a[208:211], a[64:67], 0
    v_lshlrev_b32_e32 v84, 16, v26
    v_and_b32_e32 v85, 0xffff0000, v26
    v_mfma_f32_16x16x32_bf16 v[100:103], a[212:215], a[68:71], v[100:103]
    v_lshlrev_b32_e32 v86, 16, v27
    v_and_b32_e32 v87, 0xffff0000, v27
    v_mfma_f32_16x16x32_bf16 v[104:107], v[128:131], a[64:67], 0
    v_lshlrev_b32_e32 v88, 16, v28
    v_and_b32_e32 v89, 0xffff0000, v28
    v_mfma_f32_16x16x32_bf16 v[104:107], v[132:135], a[68:71], v[104:107]
    v_lshlrev_b32_e32 v90, 16, v29
    v_and_b32_e32 v91, 0xffff0000, v29
    v_mfma_f32_16x16x32_bf16 v[108:111], v[160:163], a[64:67], 0
    v_lshlrev_b32_e32 v92, 16, v30
    v_and_b32_e32 v93, 0xffff0000, v30
    v_mfma_f32_16x16x32_bf16 v[108:111], v[164:167], a[68:71], v[108:111]
    v_lshlrev_b32_e32 v94, 16, v31
    v_and_b32_e32 v95, 0xffff0000, v31
    v_pk_mul_f32 v[80:81], v[80:81], v[22:23] op_sel_hi:[1,0]
    v_pk_mul_f32 v[82:83], v[82:83], v[22:23] op_sel_hi:[1,0]
    v_pk_mul_f32 v[84:85], v[84:85], v[22:23] op_sel_hi:[1,0]
    v_pk_mul_f32 v[86:87], v[86:87], v[22:23] op_sel_hi:[1,0]
    v_pk_mul_f32 v[88:89], v[88:89], v[22:23] op_sel_hi:[1,0]
    v_pk_mul_f32 v[90:91], v[90:91], v[22:23] op_sel_hi:[1,0]
    v_pk_mul_f32 v[92:93], v[92:93], v[22:23] op_sel_hi:[1,0]
    v_pk_mul_f32 v[94:95], v[94:95], v[22:23] op_sel_hi:[1,0]
    s_waitcnt vmcnt(4)
    ds_read_b128 v[24:27], v20 offset:2048
    ds_read_b128 v[28:31], v21 offset:2048
    buffer_load_dwordx4 v242, s[8:11], s26 offen offset:2048 nt lds
    buffer_load_dwordx4 v242, s[8:11], s27 offen offset:3072 nt lds
    v_cvt_pk_bf16_f32 v80, v80, v81
    v_cvt_pk_bf16_f32 v82, v82, v83
    v_cvt_pk_bf16_f32 v84, v84, v85
    v_cvt_pk_bf16_f32 v86, v86, v87
    v_cvt_pk_bf16_f32 v88, v88, v89
    v_cvt_pk_bf16_f32 v90, v90, v91
    v_cvt_pk_bf16_f32 v92, v92, v93
    v_cvt_pk_bf16_f32 v94, v94, v95
    v_accvgpr_write_b32 a72, v80
    v_accvgpr_write_b32 a73, v82
    v_accvgpr_write_b32 a74, v84
    v_accvgpr_write_b32 a75, v86
    v_accvgpr_write_b32 a76, v88
    v_accvgpr_write_b32 a77, v90
    v_accvgpr_write_b32 a78, v92
    v_accvgpr_write_b32 a79, v94
    s_nop 0
    s_waitcnt lgkmcnt(0)
    v_mfma_f32_16x16x32_bf16 v[96:99], a[184:187], a[72:75], v[96:99]
    v_lshlrev_b32_e32 v80, 16, v24
    v_and_b32_e32 v81, 0xffff0000, v24
    v_mfma_f32_16x16x32_bf16 v[96:99], a[188:191], a[76:79], v[96:99]
    v_lshlrev_b32_e32 v82, 16, v25
    v_and_b32_e32 v83, 0xffff0000, v25
    v_mfma_f32_16x16x32_bf16 v[100:103], a[216:219], a[72:75], v[100:103]
    v_lshlrev_b32_e32 v84, 16, v26
    v_and_b32_e32 v85, 0xffff0000, v26
    v_mfma_f32_16x16x32_bf16 v[100:103], a[220:223], a[76:79], v[100:103]
    v_lshlrev_b32_e32 v86, 16, v27
    v_and_b32_e32 v87, 0xffff0000, v27
    v_mfma_f32_16x16x32_bf16 v[104:107], v[136:139], a[72:75], v[104:107]
    v_lshlrev_b32_e32 v88, 16, v28
    v_and_b32_e32 v89, 0xffff0000, v28
    v_mfma_f32_16x16x32_bf16 v[104:107], v[140:143], a[76:79], v[104:107]
    v_lshlrev_b32_e32 v90, 16, v29
    v_and_b32_e32 v91, 0xffff0000, v29
    v_mfma_f32_16x16x32_bf16 v[108:111], v[168:171], a[72:75], v[108:111]
    v_lshlrev_b32_e32 v92, 16, v30
    v_and_b32_e32 v93, 0xffff0000, v30
    v_mfma_f32_16x16x32_bf16 v[108:111], v[172:175], a[76:79], v[108:111]
    v_lshlrev_b32_e32 v94, 16, v31
    v_and_b32_e32 v95, 0xffff0000, v31
    v_pk_mul_f32 v[80:81], v[80:81], v[22:23] op_sel_hi:[1,0]
    v_pk_mul_f32 v[82:83], v[82:83], v[22:23] op_sel_hi:[1,0]
    v_pk_mul_f32 v[84:85], v[84:85], v[22:23] op_sel_hi:[1,0]
    v_pk_mul_f32 v[86:87], v[86:87], v[22:23] op_sel_hi:[1,0]
    v_pk_mul_f32 v[88:89], v[88:89], v[22:23] op_sel_hi:[1,0]
    v_pk_mul_f32 v[90:91], v[90:91], v[22:23] op_sel_hi:[1,0]
    v_pk_mul_f32 v[92:93], v[92:93], v[22:23] op_sel_hi:[1,0]
    v_pk_mul_f32 v[94:95], v[94:95], v[22:23] op_sel_hi:[1,0]
    s_waitcnt vmcnt(4)
    ds_read_b128 v[24:27], v20 offset:3072
    ds_read_b128 v[28:31], v21 offset:3072
    s_add_u32 m0, s32, 49152
    s_add_u32 s8, s8, 0x4000
    s_addc_u32 s9, s9, 0
    buffer_load_dwordx4 v242, s[8:11], s24 offen offset:0 nt lds
    buffer_load_dwordx4 v242, s[8:11], s25 offen offset:1024 nt lds
    buffer_load_dwordx4 v242, s[8:11], s26 offen offset:2048 nt lds
    buffer_load_dwordx4 v242, s[8:11], s27 offen offset:3072 nt lds
    v_cvt_pk_bf16_f32 v80, v80, v81
    v_cvt_pk_bf16_f32 v82, v82, v83
    v_cvt_pk_bf16_f32 v84, v84, v85
    v_cvt_pk_bf16_f32 v86, v86, v87
    v_cvt_pk_bf16_f32 v88, v88, v89
    v_cvt_pk_bf16_f32 v90, v90, v91
    v_cvt_pk_bf16_f32 v92, v92, v93
    v_cvt_pk_bf16_f32 v94, v94, v95
    v_accvgpr_write_b32 a80, v80
    v_accvgpr_write_b32 a81, v82
    v_accvgpr_write_b32 a82, v84
    v_accvgpr_write_b32 a83, v86
    v_accvgpr_write_b32 a84, v88
    v_accvgpr_write_b32 a85, v90
    v_accvgpr_write_b32 a86, v92
    v_accvgpr_write_b32 a87, v94
    s_nop 0
    s_waitcnt lgkmcnt(0)
    v_mfma_f32_16x16x32_bf16 v[96:99], a[192:195], a[80:83], v[96:99]
    v_lshlrev_b32_e32 v80, 16, v24
    v_and_b32_e32 v81, 0xffff0000, v24
    v_mfma_f32_16x16x32_bf16 v[96:99], a[196:199], a[84:87], v[96:99]
    v_lshlrev_b32_e32 v82, 16, v25
    v_and_b32_e32 v83, 0xffff0000, v25
    v_mfma_f32_16x16x32_bf16 v[100:103], a[224:227], a[80:83], v[100:103]
    v_lshlrev_b32_e32 v84, 16, v26
    v_and_b32_e32 v85, 0xffff0000, v26
    v_mfma_f32_16x16x32_bf16 v[100:103], a[228:231], a[84:87], v[100:103]
    v_lshlrev_b32_e32 v86, 16, v27
    v_and_b32_e32 v87, 0xffff0000, v27
    v_mfma_f32_16x16x32_bf16 v[104:107], v[144:147], a[80:83], v[104:107]
    v_lshlrev_b32_e32 v88, 16, v28
    v_and_b32_e32 v89, 0xffff0000, v28
    v_mfma_f32_16x16x32_bf16 v[104:107], v[148:151], a[84:87], v[104:107]
    v_lshlrev_b32_e32 v90, 16, v29
    v_and_b32_e32 v91, 0xffff0000, v29
    v_mfma_f32_16x16x32_bf16 v[108:111], v[176:179], a[80:83], v[108:111]
    v_lshlrev_b32_e32 v92, 16, v30
    v_and_b32_e32 v93, 0xffff0000, v30
    v_mfma_f32_16x16x32_bf16 v[108:111], v[180:183], a[84:87], v[108:111]
    v_lshlrev_b32_e32 v94, 16, v31
    v_and_b32_e32 v95, 0xffff0000, v31
    v_pk_mul_f32 v[80:81], v[80:81], v[22:23] op_sel_hi:[1,0]
    v_pk_mul_f32 v[82:83], v[82:83], v[22:23] op_sel_hi:[1,0]
    v_pk_mul_f32 v[84:85], v[84:85], v[22:23] op_sel_hi:[1,0]
    v_pk_mul_f32 v[86:87], v[86:87], v[22:23] op_sel_hi:[1,0]
    v_pk_mul_f32 v[88:89], v[88:89], v[22:23] op_sel_hi:[1,0]
    v_pk_mul_f32 v[90:91], v[90:91], v[22:23] op_sel_hi:[1,0]
    v_pk_mul_f32 v[92:93], v[92:93], v[22:23] op_sel_hi:[1,0]
    v_pk_mul_f32 v[94:95], v[94:95], v[22:23] op_sel_hi:[1,0]
    v_cvt_pk_bf16_f32 v80, v80, v81
    v_cvt_pk_bf16_f32 v82, v82, v83
    v_cvt_pk_bf16_f32 v84, v84, v85
    v_cvt_pk_bf16_f32 v86, v86, v87
    v_cvt_pk_bf16_f32 v88, v88, v89
    v_cvt_pk_bf16_f32 v90, v90, v91
    v_cvt_pk_bf16_f32 v92, v92, v93
    v_cvt_pk_bf16_f32 v94, v94, v95
    v_accvgpr_write_b32 a88, v80
    v_accvgpr_write_b32 a89, v82
    v_accvgpr_write_b32 a90, v84
    v_accvgpr_write_b32 a91, v86
    v_accvgpr_write_b32 a92, v88
    v_accvgpr_write_b32 a93, v90
    v_accvgpr_write_b32 a94, v92
    v_accvgpr_write_b32 a95, v94
    s_nop 1
    v_mfma_f32_16x16x32_bf16 v[96:99], a[200:203], a[88:91], v[96:99]
    v_mfma_f32_16x16x32_bf16 v[96:99], a[204:207], a[92:95], v[96:99]
    v_mfma_f32_16x16x32_bf16 v[100:103], a[232:235], a[88:91], v[100:103]
    v_mfma_f32_16x16x32_bf16 v[100:103], a[236:239], a[92:95], v[100:103]
    v_mfma_f32_16x16x32_bf16 v[104:107], v[152:155], a[88:91], v[104:107]
    v_mfma_f32_16x16x32_bf16 v[104:107], v[156:159], a[92:95], v[104:107]
    v_mfma_f32_16x16x32_bf16 v[108:111], v[184:187], a[88:91], v[108:111]
    v_mfma_f32_16x16x32_bf16 v[108:111], v[188:191], a[92:95], v[108:111]
    s_lshl_b32 s35, s31, 2
    s_add_u32 s35, s35, 32768
    s_nop 5
    v_max3_f32 v254, v96, v97, v98
    v_max3_f32 v255, v104, v105, v106
    v_max3_f32 v254, v254, v99, v100
    v_max3_f32 v255, v255, v107, v108
    v_max3_f32 v254, v254, v101, v102
    v_max3_f32 v255, v255, v109, v110
    v_max3_f32 v254, v254, v103, v111
    v_max_f32_e32 v254, v254, v255
    v_mov_b32_e32 v255, v254
    s_nop 1
    v_permlane32_swap_b32_e32 v254, v255
    v_max_f32_e32 v254, v254, v255
    v_mov_b32_e32 v255, v254
    s_nop 1
    v_permlane16_swap_b32_e32 v254, v255
    v_max_f32_e32 v254, v254, v255
    v_min_f32_e64 v250, v250, -v254
    s_waitcnt vmcnt(4)
    s_barrier
    ds_read_b128 a[96:99], v240 offset:32768
    ds_read_b128 a[100:103], v241 offset:32768
    ds_read_b128 a[104:107], v240 offset:33792
    ds_read_b128 a[108:111], v241 offset:33792
    ds_read_b128 a[112:115], v240 offset:34816
    ds_read_b128 a[116:119], v241 offset:34816
    ds_read_b128 a[120:123], v240 offset:35840
    ds_read_b128 a[124:127], v241 offset:35840
    v_mov_b32_e32 v200, v250
    v_mov_b32_e32 v201, v250
    v_mov_b32_e32 v202, v250
    v_mov_b32_e32 v203, v250
    v_add_f32_e32 v96, v96, v250
    v_add_f32_e32 v97, v97, v250
    v_add_f32_e32 v98, v98, v250
    v_add_f32_e32 v99, v99, v250
    v_add_f32_e32 v100, v100, v250
    v_add_f32_e32 v101, v101, v250
    v_add_f32_e32 v102, v102, v250
    v_add_f32_e32 v103, v103, v250
    v_add_f32_e32 v104, v104, v250
    v_add_f32_e32 v105, v105, v250
    v_add_f32_e32 v106, v106, v250
    v_add_f32_e32 v107, v107, v250
    v_add_f32_e32 v108, v108, v250
    v_add_f32_e32 v109, v109, v250
    v_add_f32_e32 v110, v110, v250
    v_add_f32_e32 v111, v111, v250
    v_exp_f32_e32 v96, v96
    v_exp_f32_e32 v97, v97
    v_exp_f32_e32 v98, v98
    v_exp_f32_e32 v99, v99
    v_exp_f32_e32 v100, v100
    v_exp_f32_e32 v101, v101
    v_exp_f32_e32 v102, v102
    v_exp_f32_e32 v103, v103
    v_exp_f32_e32 v104, v104
    v_exp_f32_e32 v105, v105
    v_exp_f32_e32 v106, v106
    v_exp_f32_e32 v107, v107
    v_exp_f32_e32 v108, v108
    v_exp_f32_e32 v109, v109
    v_exp_f32_e32 v110, v110
    v_exp_f32_e32 v111, v111
    v_cvt_pk_bf16_f32 v128, v96, v97
    v_cvt_pk_bf16_f32 v129, v98, v99
    v_cvt_pk_bf16_f32 v130, v100, v101
    v_cvt_pk_bf16_f32 v131, v102, v103
    v_cvt_pk_bf16_f32 v132, v104, v105
    v_cvt_pk_bf16_f32 v133, v106, v107
    v_cvt_pk_bf16_f32 v134, v108, v109
    v_cvt_pk_bf16_f32 v135, v110, v111
    s_waitcnt lgkmcnt(0)
    v_mfma_f32_16x16x32_bf16 v[216:219], a[96:99], a[0:3], v[192:195]
    s_add_u32 m0, s32, 65536
    ds_read_b128 a[128:131], v240 offset:40960
    v_accvgpr_read_b32 v248, a251
    v_mfma_f32_16x16x32_bf16 v[216:219], a[100:103], a[4:7], v[216:219]
    s_add_u32 s8, s8, 0x4000
    v_mfma_f32_16x16x32_bf16 v[216:219], a[104:107], a[8:11], v[216:219]
    s_addc_u32 s9, s9, 0
    ds_read_b128 a[132:135], v241 offset:40960
    v_mfma_f32_16x16x32_bf16 v[216:219], a[108:111], a[12:15], v[216:219]
    buffer_load_dwordx4 v242, s[8:11], s24 offen offset:0 nt lds
    v_mfma_f32_16x16x32_bf16 v[216:219], a[112:115], a[16:19], v[216:219]
    v_mfma_f32_16x16x32_bf16 v[216:219], a[116:119], a[20:23], v[216:219]
    ds_read_b128 a[136:139], v240 offset:41984
    v_mfma_f32_16x16x32_bf16 v[216:219], a[120:123], a[24:27], v[216:219]
    v_mfma_f32_16x16x32_bf16 v[216:219], a[124:127], a[28:31], v[216:219]
    ds_read_b128 a[140:143], v241 offset:41984
    v_mfma_f32_16x16x32_bf16 v[220:223], a[124:127], a[60:63], v[196:199]
    buffer_load_dwordx4 v242, s[8:11], s25 offen offset:1024 nt lds
    v_mfma_f32_16x16x32_bf16 v[220:223], a[120:123], a[56:59], v[220:223]
    v_mfma_f32_16x16x32_bf16 v[220:223], a[116:119], a[52:55], v[220:223]
    ds_read_b128 a[144:147], v240 offset:43008
    v_mfma_f32_16x16x32_bf16 v[220:223], a[112:115], a[48:51], v[220:223]
    v_mfma_f32_16x16x32_bf16 v[220:223], a[108:111], a[44:47], v[220:223]
    ds_read_b128 a[148:151], v241 offset:43008
    v_mfma_f32_16x16x32_bf16 v[220:223], a[104:107], a[40:43], v[220:223]
    v_exp_f32_e32 v216, v216
    v_mfma_f32_16x16x32_bf16 v[220:223], a[100:103], a[36:39], v[220:223]
    buffer_load_dwordx4 v242, s[8:11], s26 offen offset:2048 nt lds
    v_mfma_f32_16x16x32_bf16 v[220:223], a[96:99], a[32:35], v[220:223]
    ds_read_b128 a[152:155], v240 offset:44032
    v_mfma_f32_16x16x32_bf16 v[224:227], a[96:99], a[64:67], v[200:203]
    v_exp_f32_e32 v217, v217
    v_mfma_f32_16x16x32_bf16 v[224:227], a[100:103], a[68:71], v[224:227]
    ds_read_b128 a[156:159], v241 offset:44032
    v_cvt_pk_bf16_f32 v8, v216, v217
    v_mfma_f32_16x16x32_bf16 v[224:227], a[104:107], a[72:75], v[224:227]
    v_exp_f32_e32 v218, v218
    v_mfma_f32_16x16x32_bf16 v[224:227], a[108:111], a[76:79], v[224:227]
    v_exp_f32_e32 v219, v219
    v_mfma_f32_16x16x32_bf16 v[224:227], a[112:115], a[80:83], v[224:227]
    v_exp_f32_e32 v220, v220
    v_mfma_f32_16x16x32_bf16 v[224:227], a[116:119], a[84:87], v[224:227]
    buffer_load_dwordx4 v242, s[8:11], s27 offen offset:3072 nt lds
    v_mfma_f32_16x16x32_bf16 v[224:227], a[120:123], a[88:91], v[224:227]
    v_exp_f32_e32 v221, v221
    v_mfma_f32_16x16x32_bf16 v[224:227], a[124:127], a[92:95], v[224:227]
    s_waitcnt vmcnt(4) lgkmcnt(0)
    v_exp_f32_e32 v222, v222
    v_mfma_f32_16x16x32_bf16 v[228:231], a[128:131], a[0:3], v[192:195]
    s_barrier
    v_cvt_pk_bf16_f32 v9, v218, v219
    v_mfma_f32_16x16x32_bf16 v[228:231], a[132:135], a[4:7], v[228:231]
    ds_read_b128 a[96:99], v240 offset:49152
    v_cvt_pk_bf16_f32 v72, v220, v221
    v_mfma_f32_16x16x32_bf16 v[228:231], a[136:139], a[8:11], v[228:231]
    v_exp_f32_e32 v223, v223
    v_mfma_f32_16x16x32_bf16 v[228:231], a[140:143], a[12:15], v[228:231]
    ds_read_b128 a[100:103], v241 offset:49152
    v_cvt_pk_bf16_f32 v73, v222, v223
    v_mfma_f32_16x16x32_bf16 v[228:231], a[144:147], a[16:19], v[228:231]
    v_exp_f32_e32 v224, v224
    v_mfma_f32_16x16x32_bf16 v[228:231], a[148:151], a[20:23], v[228:231]
    v_exp_f32_e32 v225, v225
    v_mfma_f32_16x16x32_bf16 v[228:231], a[152:155], a[24:27], v[228:231]
    ds_read_b128 a[104:107], v240 offset:50176
    v_cvt_pk_bf16_f32 v136, v224, v225
    v_mfma_f32_16x16x32_bf16 v[228:231], a[156:159], a[28:31], v[228:231]
    v_exp_f32_e32 v226, v226
    v_mfma_f32_16x16x32_bf16 v[232:235], a[156:159], a[60:63], v[196:199]
    ds_read_b128 a[108:111], v241 offset:50176
    v_mfma_f32_16x16x32_bf16 v[232:235], a[152:155], a[56:59], v[232:235]
    v_exp_f32_e32 v227, v227
    v_mfma_f32_16x16x32_bf16 v[232:235], a[148:151], a[52:55], v[232:235]
    v_cvt_pk_bf16_f32 v137, v226, v227
    v_mfma_f32_16x16x32_bf16 v[232:235], a[144:147], a[48:51], v[232:235]
    ds_read_b128 a[112:115], v240 offset:51200
    v_mfma_f32_16x16x32_bf16 v[232:235], a[140:143], a[44:47], v[232:235]
    v_exp_f32_e32 v228, v228
    v_mfma_f32_16x16x32_bf16 v[232:235], a[136:139], a[40:43], v[232:235]
    ds_read_b128 a[116:119], v241 offset:51200
    v_mfma_f32_16x16x32_bf16 v[232:235], a[132:135], a[36:39], v[232:235]
    v_exp_f32_e32 v229, v229
    v_mfma_f32_16x16x32_bf16 v[232:235], a[128:131], a[32:35], v[232:235]
    v_exp_f32_e32 v230, v230
    v_mfma_f32_16x16x32_bf16 v[236:239], a[128:131], a[64:67], v[200:203]
    ds_read_b128 a[120:123], v240 offset:52224
    v_cvt_pk_bf16_f32 v10, v228, v229
    v_mfma_f32_16x16x32_bf16 v[236:239], a[132:135], a[68:71], v[236:239]
    v_exp_f32_e32 v231, v231
    v_mfma_f32_16x16x32_bf16 v[236:239], a[136:139], a[72:75], v[236:239]
    s_add_u32 m0, s32, 81920
    ds_read_b128 a[124:127], v241 offset:52224
    v_cvt_pk_bf16_f32 v11, v230, v231
    v_mfma_f32_16x16x32_bf16 v[236:239], a[140:143], a[76:79], v[236:239]
    s_add_u32 s8, s8, 0x4000
    v_exp_f32_e32 v232, v232
    v_mfma_f32_16x16x32_bf16 v[236:239], a[144:147], a[80:83], v[236:239]
    s_addc_u32 s9, s9, 0
    v_exp_f32_e32 v233, v233
    v_mfma_f32_16x16x32_bf16 v[236:239], a[148:151], a[84:87], v[236:239]
    v_exp_f32_e32 v234, v234
    v_mfma_f32_16x16x32_bf16 v[236:239], a[152:155], a[88:91], v[236:239]
    v_exp_f32_e32 v235, v235
    v_mfma_f32_16x16x32_bf16 v[236:239], a[156:159], a[92:95], v[236:239]
    s_waitcnt lgkmcnt(0)
    v_cvt_pk_bf16_f32 v74, v232, v233
    v_cvt_pk_bf16_f32 v75, v234, v235
    v_mfma_f32_16x16x32_bf16 v[204:207], a[96:99], a[0:3], v[192:195]
    ds_read_b128 a[128:131], v240 offset:57344
    v_mfma_f32_16x16x32_bf16 v[204:207], a[100:103], a[4:7], v[204:207]
    buffer_load_dwordx4 v242, s[8:11], s24 offen offset:0 nt lds
    v_mfma_f32_16x16x32_bf16 v[204:207], a[104:107], a[8:11], v[204:207]
    ds_read_b128 a[132:135], v241 offset:57344
    v_mfma_f32_16x16x32_bf16 v[204:207], a[108:111], a[12:15], v[204:207]
    v_exp_f32_e32 v236, v236
    v_mfma_f32_16x16x32_bf16 v[204:207], a[112:115], a[16:19], v[204:207]
    v_exp_f32_e32 v237, v237
    v_mfma_f32_16x16x32_bf16 v[204:207], a[116:119], a[20:23], v[204:207]
    ds_read_b128 a[136:139], v240 offset:58368
    v_cvt_pk_bf16_f32 v138, v236, v237
    v_mfma_f32_16x16x32_bf16 v[204:207], a[120:123], a[24:27], v[204:207]
    v_exp_f32_e32 v238, v238
    v_mfma_f32_16x16x32_bf16 v[204:207], a[124:127], a[28:31], v[204:207]
    ds_read_b128 a[140:143], v241 offset:58368
    v_mfma_f32_16x16x32_bf16 v[208:211], a[124:127], a[60:63], v[196:199]
    buffer_load_dwordx4 v242, s[8:11], s25 offen offset:1024 nt lds
    v_mfma_f32_16x16x32_bf16 v[208:211], a[120:123], a[56:59], v[208:211]
    v_exp_f32_e32 v239, v239
    v_mfma_f32_16x16x32_bf16 v[208:211], a[116:119], a[52:55], v[208:211]
    ds_read_b128 a[144:147], v240 offset:59392
    v_cvt_pk_bf16_f32 v139, v238, v239
    v_mfma_f32_16x16x32_bf16 v[208:211], a[112:115], a[48:51], v[208:211]
    v_exp_f32_e32 v204, v204
    v_mfma_f32_16x16x32_bf16 v[208:211], a[108:111], a[44:47], v[208:211]
    ds_read_b128 a[148:151], v241 offset:59392
    v_mfma_f32_16x16x32_bf16 v[208:211], a[104:107], a[40:43], v[208:211]
    v_exp_f32_e32 v205, v205
    v_mfma_f32_16x16x32_bf16 v[208:211], a[100:103], a[36:39], v[208:211]
    buffer_load_dwordx4 v242, s[8:11], s26 offen offset:2048 nt lds
    v_mfma_f32_16x16x32_bf16 v[208:211], a[96:99], a[32:35], v[208:211]
    ds_read_b128 a[152:155], v240 offset:60416
    v_cvt_pk_bf16_f32 v12, v204, v205
    v_smfmac_f32_16x16x64_bf16 a[168:171], a[172:175], v[128:135], v253
    v_mfma_f32_16x16x32_bf16 v[212:215], a[96:99], a[64:67], v[200:203]
    ds_read_b128 a[156:159], v241 offset:60416
    v_mfma_f32_16x16x32_bf16 v[212:215], a[100:103], a[68:71], v[212:215]
    v_exp_f32_e32 v206, v206
    v_mfma_f32_16x16x32_bf16 v[212:215], a[104:107], a[72:75], v[212:215]
    v_exp_f32_e32 v207, v207
    v_mfma_f32_16x16x32_bf16 v[212:215], a[108:111], a[76:79], v[212:215]
    v_exp_f32_e32 v208, v208
    v_mfma_f32_16x16x32_bf16 v[212:215], a[112:115], a[80:83], v[212:215]
    buffer_load_dwordx4 v242, s[8:11], s27 offen offset:3072 nt lds
    v_mfma_f32_16x16x32_bf16 v[212:215], a[116:119], a[84:87], v[212:215]
    v_exp_f32_e32 v209, v209
    v_mfma_f32_16x16x32_bf16 v[212:215], a[120:123], a[88:91], v[212:215]
    v_xor_b32_e32 v240, 0x10000, v240
    v_cvt_pk_bf16_f32 v13, v206, v207
    v_mfma_f32_16x16x32_bf16 v[212:215], a[124:127], a[92:95], v[212:215]
    s_waitcnt vmcnt(4) lgkmcnt(0)
    v_xor_b32_e32 v241, 0x10000, v241
    v_cvt_pk_bf16_f32 v76, v208, v209
    v_mfma_f32_16x16x32_bf16 v[216:219], a[128:131], a[0:3], v[192:195]
    s_barrier
    v_mfma_f32_16x16x32_bf16 v[216:219], a[132:135], a[4:7], v[216:219]
    ds_read_b128 a[96:99], v240 offset:0
    v_mfma_f32_16x16x32_bf16 v[216:219], a[136:139], a[8:11], v[216:219]
    v_exp_f32_e32 v210, v210
    v_mfma_f32_16x16x32_bf16 v[216:219], a[140:143], a[12:15], v[216:219]
    ds_read_b128 a[100:103], v241 offset:0
    v_mfma_f32_16x16x32_bf16 v[216:219], a[144:147], a[16:19], v[216:219]
L_pad1:
    s_cbranch_vccnz L_back
    v_exp_f32_e32 v211, v211
    v_mfma_f32_16x16x32_bf16 v[216:219], a[148:151], a[20:23], v[216:219]
    v_exp_f32_e32 v212, v212
    v_mfma_f32_16x16x32_bf16 v[216:219], a[152:155], a[24:27], v[216:219]
    ds_read_b128 a[104:107], v240 offset:1024
    v_cvt_pk_bf16_f32 v77, v210, v211
    v_mfma_f32_16x16x32_bf16 v[216:219], a[156:159], a[28:31], v[216:219]
    v_exp_f32_e32 v213, v213
    v_mfma_f32_16x16x32_bf16 v[220:223], a[156:159], a[60:63], v[196:199]
    ds_read_b128 a[108:111], v241 offset:1024
    v_cvt_pk_bf16_f32 v140, v212, v213
    v_mfma_f32_16x16x32_bf16 v[220:223], a[152:155], a[56:59], v[220:223]
    v_exp_f32_e32 v214, v214
    v_mfma_f32_16x16x32_bf16 v[220:223], a[148:151], a[52:55], v[220:223]
    v_exp_f32_e32 v215, v215
    v_mfma_f32_16x16x32_bf16 v[220:223], a[144:147], a[48:51], v[220:223]
    ds_read_b128 a[112:115], v240 offset:2048
    v_cvt_pk_bf16_f32 v141, v214, v215
    v_mfma_f32_16x16x32_bf16 v[220:223], a[140:143], a[44:47], v[220:223]
    v_exp_f32_e32 v216, v216
    v_mfma_f32_16x16x32_bf16 v[220:223], a[136:139], a[40:43], v[220:223]
    ds_read_b128 a[116:119], v241 offset:2048
    v_mfma_f32_16x16x32_bf16 v[220:223], a[132:135], a[36:39], v[220:223]
    v_exp_f32_e32 v217, v217
    v_mfma_f32_16x16x32_bf16 v[220:223], a[128:131], a[32:35], v[220:223]
    v_exp_f32_e32 v218, v218
    v_mfma_f32_16x16x32_bf16 v[224:227], a[128:131], a[64:67], v[200:203]
    ds_read_b128 a[120:123], v240 offset:3072
    v_cvt_pk_bf16_f32 v14, v216, v217
    v_mfma_f32_16x16x32_bf16 v[224:227], a[132:135], a[68:71], v[224:227]
    v_exp_f32_e32 v219, v219
    v_mfma_f32_16x16x32_bf16 v[224:227], a[136:139], a[72:75], v[224:227]
    s_add_u32 m0, s32, 98304
    ds_read_b128 a[124:127], v241 offset:3072
    v_cvt_pk_bf16_f32 v15, v218, v219
    v_mfma_f32_16x16x32_bf16 v[224:227], a[140:143], a[76:79], v[224:227]
    s_add_u32 s8, s8, 0x4000
    v_exp_f32_e32 v220, v220
    v_mfma_f32_16x16x32_bf16 v[224:227], a[144:147], a[80:83], v[224:227]
    s_addc_u32 s9, s9, 0
    v_exp_f32_e32 v221, v221
    v_mfma_f32_16x16x32_bf16 v[224:227], a[148:151], a[84:87], v[224:227]
    v_exp_f32_e32 v222, v222
    v_mfma_f32_16x16x32_bf16 v[224:227], a[152:155], a[88:91], v[224:227]
    v_exp_f32_e32 v223, v223
    v_mfma_f32_16x16x32_bf16 v[224:227], a[156:159], a[92:95], v[224:227]
    s_waitcnt lgkmcnt(0)
    v_cvt_pk_bf16_f32 v78, v220, v221
    v_cvt_pk_bf16_f32 v79, v222, v223
    v_mfma_f32_16x16x32_bf16 v[228:231], a[96:99], a[0:3], v[192:195]
    ds_read_b128 a[128:131], v240 offset:8192
    v_mfma_f32_16x16x32_bf16 v[228:231], a[100:103], a[4:7], v[228:231]
    buffer_load_dwordx4 v242, s[8:11], s24 offen offset:0 nt lds
    v_mfma_f32_16x16x32_bf16 v[228:231], a[104:107], a[8:11], v[228:231]
    ds_read_b128 a[132:135], v241 offset:8192
    v_mfma_f32_16x16x32_bf16 v[228:231], a[108:111], a[12:15], v[228:231]
    v_exp_f32_e32 v224, v224
    v_mfma_f32_16x16x32_bf16 v[228:231], a[112:115], a[16:19], v[228:231]
    v_exp_f32_e32 v225, v225
    v_mfma_f32_16x16x32_bf16 v[228:231], a[116:119], a[20:23], v[228:231]
    ds_read_b128 a[136:139], v240 offset:9216
    v_cvt_pk_bf16_f32 v142, v224, v225
    v_mfma_f32_16x16x32_bf16 v[228:231], a[120:123], a[24:27], v[228:231]
    v_exp_f32_e32 v226, v226
    v_mfma_f32_16x16x32_bf16 v[228:231], a[124:127], a[28:31], v[228:231]
    ds_read_b128 a[140:143], v241 offset:9216
    v_mfma_f32_16x16x32_bf16 v[232:235], a[124:127], a[60:63], v[196:199]
    buffer_load_dwordx4 v242, s[8:11], s25 offen offset:1024 nt lds
    v_mfma_f32_16x16x32_bf16 v[232:235], a[120:123], a[56:59], v[232:235]
    v_exp_f32_e32 v227, v227
    v_mfma_f32_16x16x32_bf16 v[232:235], a[116:119], a[52:55], v[232:235]
    ds_read_b128 a[144:147], v240 offset:10240
    v_cvt_pk_bf16_f32 v143, v226, v227
    v_mfma_f32_16x16x32_bf16 v[232:235], a[112:115], a[48:51], v[232:235]
    v_exp_f32_e32 v228, v228
    v_mfma_f32_16x16x32_bf16 v[232:235], a[108:111], a[44:47], v[232:235]
    ds_read_b128 a[148:151], v241 offset:10240
    v_mfma_f32_16x16x32_bf16 v[232:235], a[104:107], a[40:43], v[232:235]
    v_exp_f32_e32 v229, v229
    v_mfma_f32_16x16x32_bf16 v[232:235], a[100:103], a[36:39], v[232:235]
    buffer_load_dwordx4 v242, s[8:11], s26 offen offset:2048 nt lds
    v_mfma_f32_16x16x32_bf16 v[232:235], a[96:99], a[32:35], v[232:235]
    ds_read_b128 a[152:155], v240 offset:11264
    v_cvt_pk_bf16_f32 v16, v228, v229
    v_mfma_f32_16x16x32_bf16 v[236:239], a[96:99], a[64:67], v[200:203]
    v_exp_f32_e32 v230, v230
    v_mfma_f32_16x16x32_bf16 v[236:239], a[100:103], a[68:71], v[236:239]
    ds_read_b128 a[156:159], v241 offset:11264
    v_mfma_f32_16x16x32_bf16 v[236:239], a[104:107], a[72:75], v[236:239]
    v_exp_f32_e32 v231, v231
    v_mfma_f32_16x16x32_bf16 v[236:239], a[108:111], a[76:79], v[236:239]
    v_exp_f32_e32 v232, v232
    v_mfma_f32_16x16x32_bf16 v[236:239], a[112:115], a[80:83], v[236:239]
    v_exp_f32_e32 v233, v233
    v_mfma_f32_16x16x32_bf16 v[236:239], a[116:119], a[84:87], v[236:239]
    buffer_load_dwordx4 v242, s[8:11], s27 offen offset:3072 nt lds
    v_mfma_f32_16x16x32_bf16 v[236:239], a[120:123], a[88:91], v[236:239]
    v_exp_f32_e32 v234, v234
    v_mfma_f32_16x16x32_bf16 v[236:239], a[124:127], a[92:95], v[236:239]
    s_waitcnt vmcnt(4) lgkmcnt(0)
    v_exp_f32_e32 v235, v235
    v_mfma_f32_16x16x32_bf16 v[204:207], a[128:131], a[0:3], v[192:195]
    s_barrier
    v_cvt_pk_bf16_f32 v17, v230, v231
    v_mfma_f32_16x16x32_bf16 v[204:207], a[132:135], a[4:7], v[204:207]
    ds_read_b128 a[96:99], v240 offset:16384
    v_cvt_pk_bf16_f32 v80, v232, v233
    v_mfma_f32_16x16x32_bf16 v[204:207], a[136:139], a[8:11], v[204:207]
    v_exp_f32_e32 v236, v236
    v_mfma_f32_16x16x32_bf16 v[204:207], a[140:143], a[12:15], v[204:207]
    ds_read_b128 a[100:103], v241 offset:16384
    v_cvt_pk_bf16_f32 v81, v234, v235
    v_mfma_f32_16x16x32_bf16 v[204:207], a[144:147], a[16:19], v[204:207]
    v_exp_f32_e32 v237, v237
    v_mfma_f32_16x16x32_bf16 v[204:207], a[148:151], a[20:23], v[204:207]
    v_exp_f32_e32 v238, v238
    v_mfma_f32_16x16x32_bf16 v[204:207], a[152:155], a[24:27], v[204:207]
    ds_read_b128 a[104:107], v240 offset:17408
    v_cvt_pk_bf16_f32 v144, v236, v237
    v_mfma_f32_16x16x32_bf16 v[204:207], a[156:159], a[28:31], v[204:207]
    v_exp_f32_e32 v239, v239
    v_smfmac_f32_16x16x64_bf16 a[160:163], a[172:175], v[8:15], v253
    ds_read_b128 a[108:111], v241 offset:17408
    v_mfma_f32_16x16x32_bf16 v[208:211], a[156:159], a[60:63], v[196:199]
    v_cvt_pk_bf16_f32 v145, v238, v239
    v_mfma_f32_16x16x32_bf16 v[208:211], a[152:155], a[56:59], v[208:211]
    v_mfma_f32_16x16x32_bf16 v[208:211], a[148:151], a[52:55], v[208:211]
    ds_read_b128 a[112:115], v240 offset:18432
    v_mfma_f32_16x16x32_bf16 v[208:211], a[144:147], a[48:51], v[208:211]
    v_exp_f32_e32 v204, v204
    v_mfma_f32_16x16x32_bf16 v[208:211], a[140:143], a[44:47], v[208:211]
    ds_read_b128 a[116:119], v241 offset:18432
    v_mfma_f32_16x16x32_bf16 v[208:211], a[136:139], a[40:43], v[208:211]
    v_exp_f32_e32 v205, v205
    v_mfma_f32_16x16x32_bf16 v[208:211], a[132:135], a[36:39], v[208:211]
    v_exp_f32_e32 v206, v206
    v_mfma_f32_16x16x32_bf16 v[208:211], a[128:131], a[32:35], v[208:211]
    ds_read_b128 a[120:123], v240 offset:19456
    v_cvt_pk_bf16_f32 v18, v204, v205
    v_smfmac_f32_16x16x64_bf16 a[164:167], a[172:175], v[72:79], v253
    v_mfma_f32_16x16x32_bf16 v[212:215], a[128:131], a[64:67], v[200:203]
    ds_read_b128 a[124:127], v241 offset:19456
    v_mfma_f32_16x16x32_bf16 v[212:215], a[132:135], a[68:71], v[212:215]
    v_exp_f32_e32 v207, v207
    v_mfma_f32_16x16x32_bf16 v[212:215], a[136:139], a[72:75], v[212:215]
    v_exp_f32_e32 v208, v208
    v_mfma_f32_16x16x32_bf16 v[212:215], a[140:143], a[76:79], v[212:215]
    s_add_u32 m0, s32, 114688
    v_exp_f32_e32 v209, v209
    v_mfma_f32_16x16x32_bf16 v[212:215], a[144:147], a[80:83], v[212:215]
    s_add_u32 s8, s8, 0x4000
    v_exp_f32_e32 v210, v210
    v_mfma_f32_16x16x32_bf16 v[212:215], a[148:151], a[84:87], v[212:215]
    s_addc_u32 s9, s9, 0
    v_exp_f32_e32 v211, v211
    v_mfma_f32_16x16x32_bf16 v[212:215], a[152:155], a[88:91], v[212:215]
    v_cvt_pk_bf16_f32 v19, v206, v207
    v_cvt_pk_bf16_f32 v82, v208, v209
    v_mfma_f32_16x16x32_bf16 v[212:215], a[156:159], a[92:95], v[212:215]
    v_cvt_pk_bf16_f32 v83, v210, v211
    v_smfmac_f32_16x16x64_bf16 a[168:171], a[172:175], v[136:143], v253
    s_waitcnt lgkmcnt(0)
    v_mfma_f32_16x16x32_bf16 v[216:219], a[96:99], a[0:3], v[192:195]
    ds_read_b128 a[128:131], v240 offset:24576
    v_mfma_f32_16x16x32_bf16 v[216:219], a[100:103], a[4:7], v[216:219]
    buffer_load_dwordx4 v242, s[8:11], s24 offen offset:0 nt lds
    v_mfma_f32_16x16x32_bf16 v[216:219], a[104:107], a[8:11], v[216:219]
    ds_read_b128 a[132:135], v241 offset:24576
    v_mfma_f32_16x16x32_bf16 v[216:219], a[108:111], a[12:15], v[216:219]
    v_exp_f32_e32 v212, v212
    v_mfma_f32_16x16x32_bf16 v[216:219], a[112:115], a[16:19], v[216:219]
    v_exp_f32_e32 v213, v213
    v_mfma_f32_16x16x32_bf16 v[216:219], a[116:119], a[20:23], v[216:219]
    ds_read_b128 a[136:139], v240 offset:25600
    v_cvt_pk_bf16_f32 v146, v212, v213
    v_mfma_f32_16x16x32_bf16 v[216:219], a[120:123], a[24:27], v[216:219]
    v_exp_f32_e32 v214, v214
    v_mfma_f32_16x16x32_bf16 v[216:219], a[124:127], a[28:31], v[216:219]
    ds_read_b128 a[140:143], v241 offset:25600
    v_mfma_f32_16x16x32_bf16 v[220:223], a[124:127], a[60:63], v[196:199]
    buffer_load_dwordx4 v242, s[8:11], s25 offen offset:1024 nt lds
    v_mfma_f32_16x16x32_bf16 v[220:223], a[120:123], a[56:59], v[220:223]
    v_exp_f32_e32 v215, v215
    v_mfma_f32_16x16x32_bf16 v[220:223], a[116:119], a[52:55], v[220:223]
    ds_read_b128 a[144:147], v240 offset:26624
    v_cvt_pk_bf16_f32 v147, v214, v215
    v_mfma_f32_16x16x32_bf16 v[220:223], a[112:115], a[48:51], v[220:223]
    v_exp_f32_e32 v216, v216
    v_mfma_f32_16x16x32_bf16 v[220:223], a[108:111], a[44:47], v[220:223]
    ds_read_b128 a[148:151], v241 offset:26624
    v_mfma_f32_16x16x32_bf16 v[220:223], a[104:107], a[40:43], v[220:223]
    v_exp_f32_e32 v217, v217
    v_mfma_f32_16x16x32_bf16 v[220:223], a[100:103], a[36:39], v[220:223]
    buffer_load_dwordx4 v242, s[8:11], s26 offen offset:2048 nt lds
    v_mfma_f32_16x16x32_bf16 v[220:223], a[96:99], a[32:35], v[220:223]
    ds_read_b128 a[152:155], v240 offset:27648
    v_cvt_pk_bf16_f32 v20, v216, v217
    v_mfma_f32_16x16x32_bf16 v[224:227], a[96:99], a[64:67], v[200:203]
    v_exp_f32_e32 v218, v218
    v_mfma_f32_16x16x32_bf16 v[224:227], a[100:103], a[68:71], v[224:227]
    ds_read_b128 a[156:159], v241 offset:27648
    v_mfma_f32_16x16x32_bf16 v[224:227], a[104:107], a[72:75], v[224:227]
    v_exp_f32_e32 v219, v219
    v_mfma_f32_16x16x32_bf16 v[224:227], a[108:111], a[76:79], v[224:227]
    v_exp_f32_e32 v220, v220
    v_mfma_f32_16x16x32_bf16 v[224:227], a[112:115], a[80:83], v[224:227]
    v_exp_f32_e32 v221, v221
    v_mfma_f32_16x16x32_bf16 v[224:227], a[116:119], a[84:87], v[224:227]
    buffer_load_dwordx4 v242, s[8:11], s27 offen offset:3072 nt lds
    v_mfma_f32_16x16x32_bf16 v[224:227], a[120:123], a[88:91], v[224:227]
    v_exp_f32_e32 v222, v222
    v_mfma_f32_16x16x32_bf16 v[224:227], a[124:127], a[92:95], v[224:227]
    s_waitcnt vmcnt(4) lgkmcnt(0)
    v_exp_f32_e32 v223, v223
    v_mfma_f32_16x16x32_bf16 v[228:231], a[128:131], a[0:3], v[192:195]
    s_barrier
    v_cvt_pk_bf16_f32 v21, v218, v219
    v_mfma_f32_16x16x32_bf16 v[228:231], a[132:135], a[4:7], v[228:231]
    ds_read_b128 a[96:99], v240 offset:32768
    v_cvt_pk_bf16_f32 v84, v220, v221
    v_mfma_f32_16x16x32_bf16 v[228:231], a[136:139], a[8:11], v[228:231]
    v_exp_f32_e32 v224, v224
    v_mfma_f32_16x16x32_bf16 v[228:231], a[140:143], a[12:15], v[228:231]
    ds_read_b128 a[100:103], v241 offset:32768
    v_cvt_pk_bf16_f32 v85, v222, v223
    v_mfma_f32_16x16x32_bf16 v[228:231], a[144:147], a[16:19], v[228:231]
    v_exp_f32_e32 v225, v225
    v_mfma_f32_16x16x32_bf16 v[228:231], a[148:151], a[20:23], v[228:231]
    v_exp_f32_e32 v226, v226
    v_mfma_f32_16x16x32_bf16 v[228:231], a[152:155], a[24:27], v[228:231]
    s_add_u32 m0, s32, 131072
    ds_read_b128 a[104:107], v240 offset:33792
    v_cvt_pk_bf16_f32 v148, v224, v225
    v_mfma_f32_16x16x32_bf16 v[228:231], a[156:159], a[28:31], v[228:231]
    s_add_u32 s8, s8, 0x4000
    v_exp_f32_e32 v227, v227
    v_mfma_f32_16x16x32_bf16 v[232:235], a[156:159], a[60:63], v[196:199]
    s_addc_u32 s9, s9, 0
    ds_read_b128 a[108:111], v241 offset:33792
    v_cvt_pk_bf16_f32 v149, v226, v227
    v_mfma_f32_16x16x32_bf16 v[232:235], a[152:155], a[56:59], v[232:235]
    v_mfma_f32_16x16x32_bf16 v[232:235], a[148:151], a[52:55], v[232:235]
    v_exp_f32_e32 v228, v228
    v_mfma_f32_16x16x32_bf16 v[232:235], a[144:147], a[48:51], v[232:235]
    ds_read_b128 a[112:115], v240 offset:34816
    v_mfma_f32_16x16x32_bf16 v[232:235], a[140:143], a[44:47], v[232:235]
    buffer_load_dwordx4 v242, s[8:11], s24 offen offset:0 nt lds
    v_mfma_f32_16x16x32_bf16 v[232:235], a[136:139], a[40:43], v[232:235]
    ds_read_b128 a[116:119], v241 offset:34816
    v_mfma_f32_16x16x32_bf16 v[232:235], a[132:135], a[36:39], v[232:235]
    v_exp_f32_e32 v229, v229
    v_mfma_f32_16x16x32_bf16 v[232:235], a[128:131], a[32:35], v[232:235]
    v_exp_f32_e32 v230, v230
    v_mfma_f32_16x16x32_bf16 v[236:239], a[128:131], a[64:67], v[200:203]
    ds_read_b128 a[120:123], v240 offset:35840
    v_cvt_pk_bf16_f32 v22, v228, v229
    v_mfma_f32_16x16x32_bf16 v[236:239], a[132:135], a[68:71], v[236:239]
    v_exp_f32_e32 v231, v231
    v_mfma_f32_16x16x32_bf16 v[236:239], a[136:139], a[72:75], v[236:239]
    ds_read_b128 a[124:127], v241 offset:35840
    v_cvt_pk_bf16_f32 v23, v230, v231
    v_mfma_f32_16x16x32_bf16 v[236:239], a[140:143], a[76:79], v[236:239]
    buffer_load_dwordx4 v242, s[8:11], s25 offen offset:1024 nt lds
    v_mfma_f32_16x16x32_bf16 v[236:239], a[144:147], a[80:83], v[236:239]
    v_exp_f32_e32 v232, v232
    v_mfma_f32_16x16x32_bf16 v[236:239], a[148:151], a[84:87], v[236:239]
    v_exp_f32_e32 v233, v233
    v_mfma_f32_16x16x32_bf16 v[236:239], a[152:155], a[88:91], v[236:239]
    v_exp_f32_e32 v234, v234
    v_mfma_f32_16x16x32_bf16 v[236:239], a[156:159], a[92:95], v[236:239]
    s_waitcnt lgkmcnt(0)
    v_exp_f32_e32 v235, v235
    v_mfma_f32_16x16x32_bf16 v[204:207], a[96:99], a[0:3], v[192:195]
    ds_read_b128 a[128:131], v240 offset:40960
    v_cvt_pk_bf16_f32 v86, v232, v233
    v_mfma_f32_16x16x32_bf16 v[204:207], a[100:103], a[4:7], v[204:207]
    v_cvt_pk_bf16_f32 v87, v234, v235
    v_mfma_f32_16x16x32_bf16 v[204:207], a[104:107], a[8:11], v[204:207]
    ds_read_b128 a[132:135], v241 offset:40960
    v_mfma_f32_16x16x32_bf16 v[204:207], a[108:111], a[12:15], v[204:207]
    buffer_load_dwordx4 v242, s[8:11], s26 offen offset:2048 nt lds
    v_mfma_f32_16x16x32_bf16 v[204:207], a[112:115], a[16:19], v[204:207]
    v_exp_f32_e32 v236, v236
    v_mfma_f32_16x16x32_bf16 v[204:207], a[116:119], a[20:23], v[204:207]
    ds_read_b128 a[136:139], v240 offset:41984
    v_mfma_f32_16x16x32_bf16 v[204:207], a[120:123], a[24:27], v[204:207]
    v_exp_f32_e32 v237, v237
    v_mfma_f32_16x16x32_bf16 v[204:207], a[124:127], a[28:31], v[204:207]
    ds_read_b128 a[140:143], v241 offset:41984
    v_cvt_pk_bf16_f32 v150, v236, v237
    v_mfma_f32_16x16x32_bf16 v[208:211], a[124:127], a[60:63], v[196:199]
    v_exp_f32_e32 v238, v238
    v_mfma_f32_16x16x32_bf16 v[208:211], a[120:123], a[56:59], v[208:211]
    buffer_load_dwordx4 v242, s[8:11], s27 offen offset:3072 nt lds
    v_mfma_f32_16x16x32_bf16 v[208:211], a[116:119], a[52:55], v[208:211]
    ds_read_b128 a[144:147], v240 offset:43008
    v_mfma_f32_16x16x32_bf16 v[208:211], a[112:115], a[48:51], v[208:211]
    v_exp_f32_e32 v239, v239
    v_mfma_f32_16x16x32_bf16 v[208:211], a[108:111], a[44:47], v[208:211]
    ds_read_b128 a[148:151], v241 offset:43008
    v_cvt_pk_bf16_f32 v151, v238, v239
    v_mfma_f32_16x16x32_bf16 v[208:211], a[104:107], a[40:43], v[208:211]
    v_exp_f32_e32 v204, v204
    v_mfma_f32_16x16x32_bf16 v[208:211], a[100:103], a[36:39], v[208:211]
    v_exp_f32_e32 v205, v205
    v_mfma_f32_16x16x32_bf16 v[208:211], a[96:99], a[32:35], v[208:211]
    ds_read_b128 a[152:155], v240 offset:44032
    v_cvt_pk_bf16_f32 v24, v204, v205
    v_mfma_f32_16x16x32_bf16 v[212:215], a[96:99], a[64:67], v[200:203]
    v_exp_f32_e32 v206, v206
    v_mfma_f32_16x16x32_bf16 v[212:215], a[100:103], a[68:71], v[212:215]
    ds_read_b128 a[156:159], v241 offset:44032
    v_mfma_f32_16x16x32_bf16 v[212:215], a[104:107], a[72:75], v[212:215]
    v_exp_f32_e32 v207, v207
    v_mfma_f32_16x16x32_bf16 v[212:215], a[108:111], a[76:79], v[212:215]
    s_add_u32 m0, s32, 147456
    v_exp_f32_e32 v208, v208
    v_mfma_f32_16x16x32_bf16 v[212:215], a[112:115], a[80:83], v[212:215]
    s_add_u32 s8, s8, 0x4000
    v_exp_f32_e32 v209, v209
    v_mfma_f32_16x16x32_bf16 v[212:215], a[116:119], a[84:87], v[212:215]
    s_addc_u32 s9, s9, 0
    v_exp_f32_e32 v210, v210
    v_mfma_f32_16x16x32_bf16 v[212:215], a[120:123], a[88:91], v[212:215]
    v_exp_f32_e32 v211, v211
    v_mfma_f32_16x16x32_bf16 v[212:215], a[124:127], a[92:95], v[212:215]
    s_waitcnt vmcnt(4) lgkmcnt(0)
    v_cvt_pk_bf16_f32 v25, v206, v207
    v_cvt_pk_bf16_f32 v88, v208, v209
    v_mfma_f32_16x16x32_bf16 v[216:219], a[128:131], a[0:3], v[192:195]
    s_barrier
    v_cvt_pk_bf16_f32 v89, v210, v211
    v_mfma_f32_16x16x32_bf16 v[216:219], a[132:135], a[4:7], v[216:219]
    ds_read_b128 a[96:99], v240 offset:49152
    v_mfma_f32_16x16x32_bf16 v[216:219], a[136:139], a[8:11], v[216:219]
    buffer_load_dwordx4 v242, s[8:11], s24 offen offset:0 nt lds
    v_mfma_f32_16x16x32_bf16 v[216:219], a[140:143], a[12:15], v[216:219]
    ds_read_b128 a[100:103], v241 offset:49152
    v_mfma_f32_16x16x32_bf16 v[216:219], a[144:147], a[16:19], v[216:219]
    v_exp_f32_e32 v212, v212
    v_mfma_f32_16x16x32_bf16 v[216:219], a[148:151], a[20:23], v[216:219]
    v_exp_f32_e32 v213, v213
    v_mfma_f32_16x16x32_bf16 v[216:219], a[152:155], a[24:27], v[216:219]
    ds_read_b128 a[104:107], v240 offset:50176
    v_cvt_pk_bf16_f32 v152, v212, v213
    v_mfma_f32_16x16x32_bf16 v[216:219], a[156:159], a[28:31], v[216:219]
    v_exp_f32_e32 v214, v214
    v_smfmac_f32_16x16x64_bf16 a[160:163], a[172:175], v[16:23], v253
    ds_read_b128 a[108:111], v241 offset:50176
    v_mfma_f32_16x16x32_bf16 v[220:223], a[156:159], a[60:63], v[196:199]
    buffer_load_dwordx4 v242, s[8:11], s25 offen offset:1024 nt lds
    v_mfma_f32_16x16x32_bf16 v[220:223], a[152:155], a[56:59], v[220:223]
    v_exp_f32_e32 v215, v215
    v_mfma_f32_16x16x32_bf16 v[220:223], a[148:151], a[52:55], v[220:223]
    ds_read_b128 a[112:115], v240 offset:51200
    v_cvt_pk_bf16_f32 v153, v214, v215
    v_mfma_f32_16x16x32_bf16 v[220:223], a[144:147], a[48:51], v[220:223]
    v_exp_f32_e32 v216, v216
    v_mfma_f32_16x16x32_bf16 v[220:223], a[140:143], a[44:47], v[220:223]
    ds_read_b128 a[116:119], v241 offset:51200
    v_mfma_f32_16x16x32_bf16 v[220:223], a[136:139], a[40:43], v[220:223]
    v_exp_f32_e32 v217, v217
    v_mfma_f32_16x16x32_bf16 v[220:223], a[132:135], a[36:39], v[220:223]
    buffer_load_dwordx4 v242, s[8:11], s26 offen offset:2048 nt lds
    v_mfma_f32_16x16x32_bf16 v[220:223], a[128:131], a[32:35], v[220:223]
    ds_read_b128 a[120:123], v240 offset:52224
    v_cvt_pk_bf16_f32 v26, v216, v217
    v_smfmac_f32_16x16x64_bf16 a[164:167], a[172:175], v[80:87], v253
    v_mfma_f32_16x16x32_bf16 v[224:227], a[128:131], a[64:67], v[200:203]
    ds_read_b128 a[124:127], v241 offset:52224
    v_mfma_f32_16x16x32_bf16 v[224:227], a[132:135], a[68:71], v[224:227]
    v_exp_f32_e32 v218, v218
    v_mfma_f32_16x16x32_bf16 v[224:227], a[136:139], a[72:75], v[224:227]
    v_exp_f32_e32 v219, v219
    v_mfma_f32_16x16x32_bf16 v[224:227], a[140:143], a[76:79], v[224:227]
    v_exp_f32_e32 v220, v220
    v_mfma_f32_16x16x32_bf16 v[224:227], a[144:147], a[80:83], v[224:227]
    buffer_load_dwordx4 v242, s[8:11], s27 offen offset:3072 nt lds
    v_mfma_f32_16x16x32_bf16 v[224:227], a[148:151], a[84:87], v[224:227]
    v_exp_f32_e32 v221, v221
    v_mfma_f32_16x16x32_bf16 v[224:227], a[152:155], a[88:91], v[224:227]
    v_exp_f32_e32 v222, v222
    v_mfma_f32_16x16x32_bf16 v[224:227], a[156:159], a[92:95], v[224:227]
    v_exp_f32_e32 v223, v223
    v_smfmac_f32_16x16x64_bf16 a[168:171], a[172:175], v[144:151], v253
    s_waitcnt lgkmcnt(0)
    v_cvt_pk_bf16_f32 v27, v218, v219
    v_mfma_f32_16x16x32_bf16 v[228:231], a[96:99], a[0:3], v[192:195]
    ds_read_b128 a[128:131], v240 offset:57344
    v_cvt_pk_bf16_f32 v90, v220, v221
    v_mfma_f32_16x16x32_bf16 v[228:231], a[100:103], a[4:7], v[228:231]
    v_exp_f32_e32 v224, v224
    v_mfma_f32_16x16x32_bf16 v[228:231], a[104:107], a[8:11], v[228:231]
    ds_read_b128 a[132:135], v241 offset:57344
    v_cvt_pk_bf16_f32 v91, v222, v223
    v_mfma_f32_16x16x32_bf16 v[228:231], a[108:111], a[12:15], v[228:231]
    v_exp_f32_e32 v225, v225
    v_mfma_f32_16x16x32_bf16 v[228:231], a[112:115], a[16:19], v[228:231]
    v_exp_f32_e32 v226, v226
    v_mfma_f32_16x16x32_bf16 v[228:231], a[116:119], a[20:23], v[228:231]
    ds_read_b128 a[136:139], v240 offset:58368
    v_cvt_pk_bf16_f32 v154, v224, v225
    v_mfma_f32_16x16x32_bf16 v[228:231], a[120:123], a[24:27], v[228:231]
    v_exp_f32_e32 v227, v227
    v_mfma_f32_16x16x32_bf16 v[228:231], a[124:127], a[28:31], v[228:231]
    s_mov_b32 m0, s32
    ds_read_b128 a[140:143], v241 offset:58368
    v_cvt_pk_bf16_f32 v155, v226, v227
    v_mfma_f32_16x16x32_bf16 v[232:235], a[124:127], a[60:63], v[196:199]
    s_add_u32 s8, s8, 0x4000
    v_mfma_f32_16x16x32_bf16 v[232:235], a[120:123], a[56:59], v[232:235]
    s_addc_u32 s9, s9, 0
    v_mfma_f32_16x16x32_bf16 v[232:235], a[116:119], a[52:55], v[232:235]
    ds_read_b128 a[144:147], v240 offset:59392
    v_mfma_f32_16x16x32_bf16 v[232:235], a[112:115], a[48:51], v[232:235]
    v_exp_f32_e32 v228, v228
    v_mfma_f32_16x16x32_bf16 v[232:235], a[108:111], a[44:47], v[232:235]
    ds_read_b128 a[148:151], v241 offset:59392
    v_mfma_f32_16x16x32_bf16 v[232:235], a[104:107], a[40:43], v[232:235]
    buffer_load_dwordx4 v242, s[8:11], s24 offen offset:0 nt lds
    v_mfma_f32_16x16x32_bf16 v[232:235], a[100:103], a[36:39], v[232:235]
    v_exp_f32_e32 v229, v229
    v_mfma_f32_16x16x32_bf16 v[232:235], a[96:99], a[32:35], v[232:235]
    ds_read_b128 a[152:155], v240 offset:60416
    v_cvt_pk_bf16_f32 v28, v228, v229
    v_mfma_f32_16x16x32_bf16 v[236:239], a[96:99], a[64:67], v[200:203]
    v_exp_f32_e32 v230, v230
    v_mfma_f32_16x16x32_bf16 v[236:239], a[100:103], a[68:71], v[236:239]
    ds_read_b128 a[156:159], v241 offset:60416
    v_mfma_f32_16x16x32_bf16 v[236:239], a[104:107], a[72:75], v[236:239]
    v_exp_f32_e32 v231, v231
    v_mfma_f32_16x16x32_bf16 v[236:239], a[108:111], a[76:79], v[236:239]
    v_exp_f32_e32 v232, v232
    v_mfma_f32_16x16x32_bf16 v[236:239], a[112:115], a[80:83], v[236:239]
    v_exp_f32_e32 v233, v233
    v_mfma_f32_16x16x32_bf16 v[236:239], a[116:119], a[84:87], v[236:239]
    v_exp_f32_e32 v234, v234
    v_mfma_f32_16x16x32_bf16 v[236:239], a[120:123], a[88:91], v[236:239]
    v_xor_b32_e32 v240, 0x30000, v240
    v_cvt_pk_bf16_f32 v29, v230, v231
    v_mfma_f32_16x16x32_bf16 v[236:239], a[124:127], a[92:95], v[236:239]
    s_waitcnt vmcnt(5) lgkmcnt(0)
    v_xor_b32_e32 v241, 0x30000, v241
    v_cvt_pk_bf16_f32 v92, v232, v233
    v_mfma_f32_16x16x32_bf16 v[204:207], a[128:131], a[0:3], v[192:195]
    s_barrier
    v_mfma_f32_16x16x32_bf16 v[204:207], a[132:135], a[4:7], v[204:207]
    ds_read_b128 a[96:99], v240 offset:0
    v_mfma_f32_16x16x32_bf16 v[204:207], a[136:139], a[8:11], v[204:207]
    buffer_load_dwordx4 v242, s[8:11], s25 offen offset:1024 nt lds
    v_mfma_f32_16x16x32_bf16 v[204:207], a[140:143], a[12:15], v[204:207]
    ds_read_b128 a[100:103], v241 offset:0
    v_mfma_f32_16x16x32_bf16 v[204:207], a[144:147], a[16:19], v[204:207]
    v_exp_f32_e32 v235, v235
    v_mfma_f32_16x16x32_bf16 v[204:207], a[148:151], a[20:23], v[204:207]
    v_exp_f32_e32 v236, v236
    v_mfma_f32_16x16x32_bf16 v[204:207], a[152:155], a[24:27], v[204:207]
    ds_read_b128 a[104:107], v240 offset:1024
    v_cvt_pk_bf16_f32 v93, v234, v235
    v_mfma_f32_16x16x32_bf16 v[204:207], a[156:159], a[28:31], v[204:207]
    buffer_load_dwordx4 v242, s[8:11], s26 offen offset:2048 nt lds
    v_mfma_f32_16x16x32_bf16 v[208:211], a[156:159], a[60:63], v[196:199]
    ds_read_b128 a[108:111], v241 offset:1024
    v_mfma_f32_16x16x32_bf16 v[208:211], a[152:155], a[56:59], v[208:211]
    v_exp_f32_e32 v237, v237
    v_mfma_f32_16x16x32_bf16 v[208:211], a[148:151], a[52:55], v[208:211]
    v_exp_f32_e32 v238, v238
    v_mfma_f32_16x16x32_bf16 v[208:211], a[144:147], a[48:51], v[208:211]
    ds_read_b128 a[112:115], v240 offset:2048
    v_cvt_pk_bf16_f32 v156, v236, v237
    v_mfma_f32_16x16x32_bf16 v[208:211], a[140:143], a[44:47], v[208:211]
    v_exp_f32_e32 v239, v239
    v_mfma_f32_16x16x32_bf16 v[208:211], a[136:139], a[40:43], v[208:211]
    ds_read_b128 a[116:119], v241 offset:2048
    v_cvt_pk_bf16_f32 v157, v238, v239
    v_mfma_f32_16x16x32_bf16 v[208:211], a[132:135], a[36:39], v[208:211]
    v_exp_f32_e32 v204, v204
    v_mfma_f32_16x16x32_bf16 v[208:211], a[128:131], a[32:35], v[208:211]
    v_exp_f32_e32 v205, v205
    v_mfma_f32_16x16x32_bf16 v[212:215], a[128:131], a[64:67], v[200:203]
    ds_read_b128 a[120:123], v240 offset:3072
    v_cvt_pk_bf16_f32 v30, v204, v205
    v_mfma_f32_16x16x32_bf16 v[212:215], a[132:135], a[68:71], v[212:215]
    buffer_load_dwordx4 v242, s[8:11], s27 offen offset:3072 nt lds
    v_mfma_f32_16x16x32_bf16 v[212:215], a[136:139], a[72:75], v[212:215]
    ds_read_b128 a[124:127], v241 offset:3072
    v_mfma_f32_16x16x32_bf16 v[212:215], a[140:143], a[76:79], v[212:215]
    v_exp_f32_e32 v206, v206
    v_mfma_f32_16x16x32_bf16 v[212:215], a[144:147], a[80:83], v[212:215]
    s_add_u32 m0, s32, 16384
    v_exp_f32_e32 v207, v207
    v_mfma_f32_16x16x32_bf16 v[212:215], a[148:151], a[84:87], v[212:215]
    s_add_u32 s8, s8, 0x4000
    v_exp_f32_e32 v208, v208
    v_mfma_f32_16x16x32_bf16 v[212:215], a[152:155], a[88:91], v[212:215]
    s_addc_u32 s9, s9, 0
    v_exp_f32_e32 v209, v209
    v_mfma_f32_16x16x32_bf16 v[212:215], a[156:159], a[92:95], v[212:215]
    s_waitcnt lgkmcnt(0)
    v_exp_f32_e32 v210, v210
    v_mfma_f32_16x16x32_bf16 v[216:219], a[96:99], a[0:3], v[192:195]
    ds_read_b128 a[128:131], v240 offset:8192
    v_cvt_pk_bf16_f32 v31, v206, v207
    v_mfma_f32_16x16x32_bf16 v[216:219], a[100:103], a[4:7], v[216:219]
    v_exp_f32_e32 v211, v211
    v_mfma_f32_16x16x32_bf16 v[216:219], a[104:107], a[8:11], v[216:219]
    ds_read_b128 a[132:135], v241 offset:8192
    v_cvt_pk_bf16_f32 v94, v208, v209
    v_mfma_f32_16x16x32_bf16 v[216:219], a[108:111], a[12:15], v[216:219]
    buffer_load_dwordx4 v242, s[8:11], s24 offen offset:0 nt lds
    v_mfma_f32_16x16x32_bf16 v[216:219], a[112:115], a[16:19], v[216:219]
    v_exp_f32_e32 v212, v212
    v_mfma_f32_16x16x32_bf16 v[216:219], a[116:119], a[20:23], v[216:219]
    ds_read_b128 a[136:139], v240 offset:9216
    v_cvt_pk_bf16_f32 v95, v210, v211
    v_mfma_f32_16x16x32_bf16 v[216:219], a[120:123], a[24:27], v[216:219]
    v_exp_f32_e32 v213, v213
    v_mfma_f32_16x16x32_bf16 v[216:219], a[124:127], a[28:31], v[216:219]
    ds_read_b128 a[140:143], v241 offset:9216
    v_cvt_pk_bf16_f32 v158, v212, v213
    v_mfma_f32_16x16x32_bf16 v[220:223], a[124:127], a[60:63], v[196:199]
    v_exp_f32_e32 v214, v214
    v_mfma_f32_16x16x32_bf16 v[220:223], a[120:123], a[56:59], v[220:223]
    v_exp_f32_e32 v215, v215
    v_mfma_f32_16x16x32_bf16 v[220:223], a[116:119], a[52:55], v[220:223]
    ds_read_b128 a[144:147], v240 offset:10240
    v_cvt_pk_bf16_f32 v159, v214, v215
    v_mfma_f32_16x16x32_bf16 v[220:223], a[112:115], a[48:51], v[220:223]
    buffer_load_dwordx4 v242, s[8:11], s25 offen offset:1024 nt lds
    v_mfma_f32_16x16x32_bf16 v[220:223], a[108:111], a[44:47], v[220:223]
    ds_read_b128 a[148:151], v241 offset:10240
    v_mfma_f32_16x16x32_bf16 v[220:223], a[104:107], a[40:43], v[220:223]
    v_exp_f32_e32 v216, v216
    v_mfma_f32_16x16x32_bf16 v[220:223], a[100:103], a[36:39], v[220:223]
    v_exp_f32_e32 v217, v217
    v_mfma_f32_16x16x32_bf16 v[220:223], a[96:99], a[32:35], v[220:223]
    ds_read_b128 a[152:155], v240 offset:11264
    v_cvt_pk_bf16_f32 v32, v216, v217
    v_mfma_f32_16x16x32_bf16 v[224:227], a[96:99], a[64:67], v[200:203]
    v_exp_f32_e32 v218, v218
    v_mfma_f32_16x16x32_bf16 v[224:227], a[100:103], a[68:71], v[224:227]
    ds_read_b128 a[156:159], v241 offset:11264
    v_mfma_f32_16x16x32_bf16 v[224:227], a[104:107], a[72:75], v[224:227]
    v_exp_f32_e32 v219, v219
    v_mfma_f32_16x16x32_bf16 v[224:227], a[108:111], a[76:79], v[224:227]
    v_exp_f32_e32 v220, v220
    v_mfma_f32_16x16x32_bf16 v[224:227], a[112:115], a[80:83], v[224:227]
    buffer_load_dwordx4 v242, s[8:11], s26 offen offset:2048 nt lds
    v_mfma_f32_16x16x32_bf16 v[224:227], a[116:119], a[84:87], v[224:227]
    v_exp_f32_e32 v221, v221
    v_mfma_f32_16x16x32_bf16 v[224:227], a[120:123], a[88:91], v[224:227]
    v_exp_f32_e32 v222, v222
    v_mfma_f32_16x16x32_bf16 v[224:227], a[124:127], a[92:95], v[224:227]
    s_waitcnt vmcnt(7) lgkmcnt(0)
    v_exp_f32_e32 v223, v223
    v_mfma_f32_16x16x32_bf16 v[228:231], a[128:131], a[0:3], v[192:195]
    s_barrier
    v_cvt_pk_bf16_f32 v33, v218, v219
    v_mfma_f32_16x16x32_bf16 v[228:231], a[132:135], a[4:7], v[228:231]
    ds_read_b128 a[96:99], v240 offset:16384
    v_cvt_pk_bf16_f32 v96, v220, v221
    v_mfma_f32_16x16x32_bf16 v[228:231], a[136:139], a[8:11], v[228:231]
    v_exp_f32_e32 v224, v224
    v_mfma_f32_16x16x32_bf16 v[228:231], a[140:143], a[12:15], v[228:231]
    ds_read_b128 a[100:103], v241 offset:16384
    v_cvt_pk_bf16_f32 v97, v222, v223
    v_mfma_f32_16x16x32_bf16 v[228:231], a[144:147], a[16:19], v[228:231]
    v_exp_f32_e32 v225, v225
    v_mfma_f32_16x16x32_bf16 v[228:231], a[148:151], a[20:23], v[228:231]
    buffer_load_dwordx4 v242, s[8:11], s27 offen offset:3072 nt lds
    v_mfma_f32_16x16x32_bf16 v[228:231], a[152:155], a[24:27], v[228:231]
    ds_read_b128 a[104:107], v240 offset:17408
    v_cvt_pk_bf16_f32 v160, v224, v225
    v_mfma_f32_16x16x32_bf16 v[228:231], a[156:159], a[28:31], v[228:231]
    v_exp_f32_e32 v226, v226
    v_smfmac_f32_16x16x64_bf16 a[160:163], a[172:175], v[24:31], v253
    ds_read_b128 a[108:111], v241 offset:17408
    v_mfma_f32_16x16x32_bf16 v[232:235], a[156:159], a[60:63], v[196:199]
    v_exp_f32_e32 v227, v227
    v_mfma_f32_16x16x32_bf16 v[232:235], a[152:155], a[56:59], v[232:235]
    s_add_u32 m0, s32, 32768
    v_cvt_pk_bf16_f32 v161, v226, v227
    v_mfma_f32_16x16x32_bf16 v[232:235], a[148:151], a[52:55], v[232:235]
    s_add_u32 s8, s8, 0x4000
    ds_read_b128 a[112:115], v240 offset:18432
    v_mfma_f32_16x16x32_bf16 v[232:235], a[144:147], a[48:51], v[232:235]
    s_addc_u32 s9, s9, 0
    v_exp_f32_e32 v228, v228
    v_mfma_f32_16x16x32_bf16 v[232:235], a[140:143], a[44:47], v[232:235]
    ds_read_b128 a[116:119], v241 offset:18432
    v_mfma_f32_16x16x32_bf16 v[232:235], a[136:139], a[40:43], v[232:235]
L_walk1:
L_pad2:
    s_cbranch_vccnz L_pad3
    v_exp_f32_e32 v229, v229
    v_mfma_f32_16x16x32_bf16 v[232:235], a[132:135], a[36:39], v[232:235]
    v_exp_f32_e32 v230, v230
    v_mfma_f32_16x16x32_bf16 v[232:235], a[128:131], a[32:35], v[232:235]
    ds_read_b128 a[120:123], v240 offset:19456
    v_cvt_pk_bf16_f32 v34, v228, v229
    v_smfmac_f32_16x16x64_bf16 a[164:167], a[172:175], v[88:95], v253
    v_mfma_f32_16x16x32_bf16 v[236:239], a[128:131], a[64:67], v[200:203]
    ds_read_b128 a[124:127], v241 offset:19456
    v_mfma_f32_16x16x32_bf16 v[236:239], a[132:135], a[68:71], v[236:239]
    buffer_load_dwordx4 v242, s[8:11], s24 offen offset:0 nt lds
    v_mfma_f32_16x16x32_bf16 v[236:239], a[136:139], a[72:75], v[236:239]
    v_exp_f32_e32 v231, v231
    v_mfma_f32_16x16x32_bf16 v[236:239], a[140:143], a[76:79], v[236:239]
    v_exp_f32_e32 v232, v232
    v_mfma_f32_16x16x32_bf16 v[236:239], a[144:147], a[80:83], v[236:239]
    v_exp_f32_e32 v233, v233
    v_mfma_f32_16x16x32_bf16 v[236:239], a[148:151], a[84:87], v[236:239]
    v_exp_f32_e32 v234, v234
    v_mfma_f32_16x16x32_bf16 v[236:239], a[152:155], a[88:91], v[236:239]
    v_exp_f32_e32 v235, v235
    v_mfma_f32_16x16x32_bf16 v[236:239], a[156:159], a[92:95], v[236:239]
    buffer_load_dwordx4 v242, s[8:11], s25 offen offset:1024 nt lds
    v_smfmac_f32_16x16x64_bf16 a[168:171], a[172:175], v[152:159], v253
    s_waitcnt lgkmcnt(0)
    v_cvt_pk_bf16_f32 v35, v230, v231
    v_mfma_f32_16x16x32_bf16 v[204:207], a[96:99], a[0:3], v[192:195]
    ds_read_b128 a[128:131], v240 offset:24576
    v_cvt_pk_bf16_f32 v98, v232, v233
    v_mfma_f32_16x16x32_bf16 v[204:207], a[100:103], a[4:7], v[204:207]
    v_exp_f32_e32 v236, v236
    v_mfma_f32_16x16x32_bf16 v[204:207], a[104:107], a[8:11], v[204:207]
    ds_read_b128 a[132:135], v241 offset:24576
    v_cvt_pk_bf16_f32 v99, v234, v235
    v_mfma_f32_16x16x32_bf16 v[204:207], a[108:111], a[12:15], v[204:207]
    v_exp_f32_e32 v237, v237
    v_mfma_f32_16x16x32_bf16 v[204:207], a[112:115], a[16:19], v[204:207]
    v_exp_f32_e32 v238, v238
    v_mfma_f32_16x16x32_bf16 v[204:207], a[116:119], a[20:23], v[204:207]
    ds_read_b128 a[136:139], v240 offset:25600
    v_cvt_pk_bf16_f32 v162, v236, v237
    v_mfma_f32_16x16x32_bf16 v[204:207], a[120:123], a[24:27], v[204:207]
    v_exp_f32_e32 v239, v239
    v_mfma_f32_16x16x32_bf16 v[204:207], a[124:127], a[28:31], v[204:207]
    ds_read_b128 a[140:143], v241 offset:25600
    v_cvt_pk_bf16_f32 v163, v238, v239
    v_mfma_f32_16x16x32_bf16 v[208:211], a[124:127], a[60:63], v[196:199]
    buffer_load_dwordx4 v242, s[8:11], s26 offen offset:2048 nt lds
    v_mfma_f32_16x16x32_bf16 v[208:211], a[120:123], a[56:59], v[208:211]
    v_mfma_f32_16x16x32_bf16 v[208:211], a[116:119], a[52:55], v[208:211]
    ds_read_b128 a[144:147], v240 offset:26624
    v_mfma_f32_16x16x32_bf16 v[208:211], a[112:115], a[48:51], v[208:211]
    v_exp_f32_e32 v204, v204
    v_mfma_f32_16x16x32_bf16 v[208:211], a[108:111], a[44:47], v[208:211]
    ds_read_b128 a[148:151], v241 offset:26624
    v_mfma_f32_16x16x32_bf16 v[208:211], a[104:107], a[40:43], v[208:211]
    v_exp_f32_e32 v205, v205
    v_mfma_f32_16x16x32_bf16 v[208:211], a[100:103], a[36:39], v[208:211]
    v_exp_f32_e32 v206, v206
    v_mfma_f32_16x16x32_bf16 v[208:211], a[96:99], a[32:35], v[208:211]
    ds_read_b128 a[152:155], v240 offset:27648
    v_cvt_pk_bf16_f32 v36, v204, v205
    v_mfma_f32_16x16x32_bf16 v[212:215], a[96:99], a[64:67], v[200:203]
    buffer_load_dwordx4 v242, s[8:11], s27 offen offset:3072 nt lds
    v_mfma_f32_16x16x32_bf16 v[212:215], a[100:103], a[68:71], v[212:215]
    ds_read_b128 a[156:159], v241 offset:27648
    v_mfma_f32_16x16x32_bf16 v[212:215], a[104:107], a[72:75], v[212:215]
    v_exp_f32_e32 v207, v207
    v_mfma_f32_16x16x32_bf16 v[212:215], a[108:111], a[76:79], v[212:215]
    v_exp_f32_e32 v208, v208
    v_mfma_f32_16x16x32_bf16 v[212:215], a[112:115], a[80:83], v[212:215]
    v_exp_f32_e32 v209, v209
    v_mfma_f32_16x16x32_bf16 v[212:215], a[116:119], a[84:87], v[212:215]
    s_add_u32 m0, s32, 49152
    v_exp_f32_e32 v210, v210
    v_mfma_f32_16x16x32_bf16 v[212:215], a[120:123], a[88:91], v[212:215]
    s_add_u32 s8, s8, 0x4000
    v_xor_b32_e32 v240, 0x20000, v240
    v_cvt_pk_bf16_f32 v37, v206, v207
    v_mfma_f32_16x16x32_bf16 v[212:215], a[124:127], a[92:95], v[212:215]
    s_waitcnt vmcnt(8) lgkmcnt(0)
    v_xor_b32_e32 v241, 0x20000, v241
    v_cvt_pk_bf16_f32 v100, v208, v209
    v_mfma_f32_16x16x32_bf16 v[216:219], a[128:131], a[0:3], v[192:195]
    s_barrier
    v_mfma_f32_16x16x32_bf16 v[216:219], a[132:135], a[4:7], v[216:219]
    s_addc_u32 s9, s9, 0
    ds_read_b128 a[96:99], v240 offset:0
    v_mfma_f32_16x16x32_bf16 v[216:219], a[136:139], a[8:11], v[216:219]
    v_exp_f32_e32 v211, v211
    v_mfma_f32_16x16x32_bf16 v[216:219], a[140:143], a[12:15], v[216:219]
    ds_read_b128 a[100:103], v241 offset:0
    v_cvt_pk_bf16_f32 v101, v210, v211
    v_mfma_f32_16x16x32_bf16 v[216:219], a[144:147], a[16:19], v[216:219]
    buffer_load_dwordx4 v242, s[8:11], s24 offen offset:0 nt lds
    v_mfma_f32_16x16x32_bf16 v[216:219], a[148:151], a[20:23], v[216:219]
    v_exp_f32_e32 v212, v212
    v_mfma_f32_16x16x32_bf16 v[216:219], a[152:155], a[24:27], v[216:219]
    ds_read_b128 a[104:107], v240 offset:1024
    v_mfma_f32_16x16x32_bf16 v[216:219], a[156:159], a[28:31], v[216:219]
    v_exp_f32_e32 v213, v213
    v_mfma_f32_16x16x32_bf16 v[220:223], a[156:159], a[60:63], v[196:199]
    ds_read_b128 a[108:111], v241 offset:1024
    v_cvt_pk_bf16_f32 v164, v212, v213
    v_mfma_f32_16x16x32_bf16 v[220:223], a[152:155], a[56:59], v[220:223]
    v_exp_f32_e32 v214, v214
    v_mfma_f32_16x16x32_bf16 v[220:223], a[148:151], a[52:55], v[220:223]
    v_exp_f32_e32 v215, v215
    v_mfma_f32_16x16x32_bf16 v[220:223], a[144:147], a[48:51], v[220:223]
    ds_read_b128 a[112:115], v240 offset:2048
    v_cvt_pk_bf16_f32 v165, v214, v215
    v_mfma_f32_16x16x32_bf16 v[220:223], a[140:143], a[44:47], v[220:223]
    buffer_load_dwordx4 v242, s[8:11], s25 offen offset:1024 nt lds
    v_mfma_f32_16x16x32_bf16 v[220:223], a[136:139], a[40:43], v[220:223]
    ds_read_b128 a[116:119], v241 offset:2048
    v_mfma_f32_16x16x32_bf16 v[220:223], a[132:135], a[36:39], v[220:223]
    v_exp_f32_e32 v216, v216
    v_mfma_f32_16x16x32_bf16 v[220:223], a[128:131], a[32:35], v[220:223]
    v_exp_f32_e32 v217, v217
    v_mfma_f32_16x16x32_bf16 v[224:227], a[128:131], a[64:67], v[200:203]
    ds_read_b128 a[120:123], v240 offset:3072
    v_cvt_pk_bf16_f32 v38, v216, v217
    v_mfma_f32_16x16x32_bf16 v[224:227], a[132:135], a[68:71], v[224:227]
    v_exp_f32_e32 v218, v218
    v_mfma_f32_16x16x32_bf16 v[224:227], a[136:139], a[72:75], v[224:227]
    ds_read_b128 a[124:127], v241 offset:3072
    v_mfma_f32_16x16x32_bf16 v[224:227], a[140:143], a[76:79], v[224:227]
    v_exp_f32_e32 v219, v219
    v_mfma_f32_16x16x32_bf16 v[224:227], a[144:147], a[80:83], v[224:227]
    v_exp_f32_e32 v220, v220
    v_mfma_f32_16x16x32_bf16 v[224:227], a[148:151], a[84:87], v[224:227]
    buffer_load_dwordx4 v242, s[8:11], s26 offen offset:2048 nt lds
    v_mfma_f32_16x16x32_bf16 v[224:227], a[152:155], a[88:91], v[224:227]
    v_exp_f32_e32 v221, v221
    v_mfma_f32_16x16x32_bf16 v[224:227], a[156:159], a[92:95], v[224:227]
    s_waitcnt lgkmcnt(0)
    v_exp_f32_e32 v222, v222
    v_mfma_f32_16x16x32_bf16 v[228:231], a[96:99], a[0:3], v[192:195]
    ds_read_b128 a[128:131], v240 offset:8192
    v_cvt_pk_bf16_f32 v39, v218, v219
    v_mfma_f32_16x16x32_bf16 v[228:231], a[100:103], a[4:7], v[228:231]
    v_exp_f32_e32 v223, v223
    v_mfma_f32_16x16x32_bf16 v[228:231], a[104:107], a[8:11], v[228:231]
    ds_read_b128 a[132:135], v241 offset:8192
    v_cvt_pk_bf16_f32 v102, v220, v221
    v_mfma_f32_16x16x32_bf16 v[228:231], a[108:111], a[12:15], v[228:231]
    v_exp_f32_e32 v224, v224
    v_mfma_f32_16x16x32_bf16 v[228:231], a[112:115], a[16:19], v[228:231]
    v_exp_f32_e32 v225, v225
    v_mfma_f32_16x16x32_bf16 v[228:231], a[116:119], a[20:23], v[228:231]
    ds_read_b128 a[136:139], v240 offset:9216
    v_cvt_pk_bf16_f32 v103, v222, v223
    v_mfma_f32_16x16x32_bf16 v[228:231], a[120:123], a[24:27], v[228:231]
    buffer_load_dwordx4 v242, s[8:11], s27 offen offset:3072 nt lds
    v_mfma_f32_16x16x32_bf16 v[228:231], a[124:127], a[28:31], v[228:231]
    ds_read_b128 a[140:143], v241 offset:9216
    v_cvt_pk_bf16_f32 v166, v224, v225
    v_mfma_f32_16x16x32_bf16 v[232:235], a[124:127], a[60:63], v[196:199]
    v_exp_f32_e32 v226, v226
    v_mfma_f32_16x16x32_bf16 v[232:235], a[120:123], a[56:59], v[232:235]
    s_add_u32 m0, s32, 65536
    v_exp_f32_e32 v227, v227
    v_mfma_f32_16x16x32_bf16 v[232:235], a[116:119], a[52:55], v[232:235]
    s_add_u32 s8, s8, 0x4000
    ds_read_b128 a[144:147], v240 offset:10240
    v_cvt_pk_bf16_f32 v167, v226, v227
    v_mfma_f32_16x16x32_bf16 v[232:235], a[112:115], a[48:51], v[232:235]
    s_addc_u32 s9, s9, 0
    v_exp_f32_e32 v228, v228
    v_mfma_f32_16x16x32_bf16 v[232:235], a[108:111], a[44:47], v[232:235]
    ds_read_b128 a[148:151], v241 offset:10240
    v_mfma_f32_16x16x32_bf16 v[232:235], a[104:107], a[40:43], v[232:235]
    v_exp_f32_e32 v229, v229
    v_mfma_f32_16x16x32_bf16 v[232:235], a[100:103], a[36:39], v[232:235]
    v_exp_f32_e32 v230, v230
    v_mfma_f32_16x16x32_bf16 v[232:235], a[96:99], a[32:35], v[232:235]
    ds_read_b128 a[152:155], v240 offset:11264
    v_cvt_pk_bf16_f32 v40, v228, v229
    v_mfma_f32_16x16x32_bf16 v[236:239], a[96:99], a[64:67], v[200:203]
    buffer_load_dwordx4 v242, s[8:11], s24 offen offset:0 nt lds
    v_mfma_f32_16x16x32_bf16 v[236:239], a[100:103], a[68:71], v[236:239]
    ds_read_b128 a[156:159], v241 offset:11264
    v_mfma_f32_16x16x32_bf16 v[236:239], a[104:107], a[72:75], v[236:239]
    v_exp_f32_e32 v231, v231
    v_mfma_f32_16x16x32_bf16 v[236:239], a[108:111], a[76:79], v[236:239]
    v_exp_f32_e32 v232, v232
    v_mfma_f32_16x16x32_bf16 v[236:239], a[112:115], a[80:83], v[236:239]
    v_exp_f32_e32 v233, v233
    v_mfma_f32_16x16x32_bf16 v[236:239], a[116:119], a[84:87], v[236:239]
    v_exp_f32_e32 v234, v234
    v_mfma_f32_16x16x32_bf16 v[236:239], a[120:123], a[88:91], v[236:239]
    v_exp_f32_e32 v235, v235
    v_mfma_f32_16x16x32_bf16 v[236:239], a[124:127], a[92:95], v[236:239]
    s_waitcnt vmcnt(9) lgkmcnt(0)
    v_cvt_pk_bf16_f32 v41, v230, v231
    v_cvt_pk_bf16_f32 v104, v232, v233
    v_mfma_f32_16x16x32_bf16 v[204:207], a[128:131], a[0:3], v[192:195]
    s_barrier
    v_cvt_pk_bf16_f32 v105, v234, v235
    v_mfma_f32_16x16x32_bf16 v[204:207], a[132:135], a[4:7], v[204:207]
    ds_read_b128 a[96:99], v240 offset:16384
    v_mfma_f32_16x16x32_bf16 v[204:207], a[136:139], a[8:11], v[204:207]
    buffer_load_dwordx4 v242, s[8:11], s25 offen offset:1024 nt lds
    v_mfma_f32_16x16x32_bf16 v[204:207], a[140:143], a[12:15], v[204:207]
    ds_read_b128 a[100:103], v241 offset:16384
    v_mfma_f32_16x16x32_bf16 v[204:207], a[144:147], a[16:19], v[204:207]
    v_exp_f32_e32 v236, v236
    v_mfma_f32_16x16x32_bf16 v[204:207], a[148:151], a[20:23], v[204:207]
    v_exp_f32_e32 v237, v237
    v_mfma_f32_16x16x32_bf16 v[204:207], a[152:155], a[24:27], v[204:207]
    ds_read_b128 a[104:107], v240 offset:17408
    v_cvt_pk_bf16_f32 v168, v236, v237
    v_mfma_f32_16x16x32_bf16 v[204:207], a[156:159], a[28:31], v[204:207]
    v_exp_f32_e32 v238, v238
    v_smfmac_f32_16x16x64_bf16 a[160:163], a[172:175], v[32:39], v253
    ds_read_b128 a[108:111], v241 offset:17408
    v_mfma_f32_16x16x32_bf16 v[208:211], a[156:159], a[60:63], v[196:199]
    v_exp_f32_e32 v239, v239
    v_mfma_f32_16x16x32_bf16 v[208:211], a[152:155], a[56:59], v[208:211]
    v_cvt_pk_bf16_f32 v169, v238, v239
    v_mfma_f32_16x16x32_bf16 v[208:211], a[148:151], a[52:55], v[208:211]
    ds_read_b128 a[112:115], v240 offset:18432
    v_mfma_f32_16x16x32_bf16 v[208:211], a[144:147], a[48:51], v[208:211]
    buffer_load_dwordx4 v242, s[8:11], s26 offen offset:2048 nt lds
    v_mfma_f32_16x16x32_bf16 v[208:211], a[140:143], a[44:47], v[208:211]
    ds_read_b128 a[116:119], v241 offset:18432
    v_mfma_f32_16x16x32_bf16 v[208:211], a[136:139], a[40:43], v[208:211]
    v_exp_f32_e32 v204, v204
    v_mfma_f32_16x16x32_bf16 v[208:211], a[132:135], a[36:39], v[208:211]
    v_exp_f32_e32 v205, v205
    v_mfma_f32_16x16x32_bf16 v[208:211], a[128:131], a[32:35], v[208:211]
    ds_read_b128 a[120:123], v240 offset:19456
    v_cvt_pk_bf16_f32 v42, v204, v205
    v_smfmac_f32_16x16x64_bf16 a[164:167], a[172:175], v[96:103], v253
    v_mfma_f32_16x16x32_bf16 v[212:215], a[128:131], a[64:67], v[200:203]
    ds_read_b128 a[124:127], v241 offset:19456
    v_mfma_f32_16x16x32_bf16 v[212:215], a[132:135], a[68:71], v[212:215]
    v_exp_f32_e32 v206, v206
    v_mfma_f32_16x16x32_bf16 v[212:215], a[136:139], a[72:75], v[212:215]
    v_exp_f32_e32 v207, v207
    v_mfma_f32_16x16x32_bf16 v[212:215], a[140:143], a[76:79], v[212:215]
    buffer_load_dwordx4 v242, s[8:11], s27 offen offset:3072 nt lds
    v_mfma_f32_16x16x32_bf16 v[212:215], a[144:147], a[80:83], v[212:215]
    v_exp_f32_e32 v208, v208
    v_mfma_f32_16x16x32_bf16 v[212:215], a[148:151], a[84:87], v[212:215]
    v_exp_f32_e32 v209, v209
    v_mfma_f32_16x16x32_bf16 v[212:215], a[152:155], a[88:91], v[212:215]
    v_exp_f32_e32 v210, v210
    v_mfma_f32_16x16x32_bf16 v[212:215], a[156:159], a[92:95], v[212:215]
    s_add_u32 m0, s32, 81920
    v_exp_f32_e32 v211, v211
    v_smfmac_f32_16x16x64_bf16 a[168:171], a[172:175], v[160:167], v253
    s_waitcnt lgkmcnt(0)
    v_cvt_pk_bf16_f32 v43, v206, v207
    v_mfma_f32_16x16x32_bf16 v[216:219], a[96:99], a[0:3], v[192:195]
    s_add_u32 s8, s8, 0x4000
    ds_read_b128 a[128:131], v240 offset:24576
    v_cvt_pk_bf16_f32 v106, v208, v209
    v_mfma_f32_16x16x32_bf16 v[216:219], a[100:103], a[4:7], v[216:219]
    s_addc_u32 s9, s9, 0
    v_exp_f32_e32 v212, v212
    v_mfma_f32_16x16x32_bf16 v[216:219], a[104:107], a[8:11], v[216:219]
    ds_read_b128 a[132:135], v241 offset:24576
    v_cvt_pk_bf16_f32 v107, v210, v211
    v_mfma_f32_16x16x32_bf16 v[216:219], a[108:111], a[12:15], v[216:219]
    v_exp_f32_e32 v213, v213
    v_mfma_f32_16x16x32_bf16 v[216:219], a[112:115], a[16:19], v[216:219]
    buffer_load_dwordx4 v242, s[8:11], s24 offen offset:0 nt lds
    v_mfma_f32_16x16x32_bf16 v[216:219], a[116:119], a[20:23], v[216:219]
    ds_read_b128 a[136:139], v240 offset:25600
    v_cvt_pk_bf16_f32 v170, v212, v213
    v_mfma_f32_16x16x32_bf16 v[216:219], a[120:123], a[24:27], v[216:219]
    v_exp_f32_e32 v214, v214
    v_mfma_f32_16x16x32_bf16 v[216:219], a[124:127], a[28:31], v[216:219]
    ds_read_b128 a[140:143], v241 offset:25600
    v_mfma_f32_16x16x32_bf16 v[220:223], a[124:127], a[60:63], v[196:199]
    v_exp_f32_e32 v215, v215
    v_mfma_f32_16x16x32_bf16 v[220:223], a[120:123], a[56:59], v[220:223]
    v_cvt_pk_bf16_f32 v171, v214, v215
    v_mfma_f32_16x16x32_bf16 v[220:223], a[116:119], a[52:55], v[220:223]
    ds_read_b128 a[144:147], v240 offset:26624
    v_mfma_f32_16x16x32_bf16 v[220:223], a[112:115], a[48:51], v[220:223]
    v_exp_f32_e32 v216, v216
    v_mfma_f32_16x16x32_bf16 v[220:223], a[108:111], a[44:47], v[220:223]
    ds_read_b128 a[148:151], v241 offset:26624
    v_mfma_f32_16x16x32_bf16 v[220:223], a[104:107], a[40:43], v[220:223]
    buffer_load_dwordx4 v242, s[8:11], s25 offen offset:1024 nt lds
    v_mfma_f32_16x16x32_bf16 v[220:223], a[100:103], a[36:39], v[220:223]
    v_exp_f32_e32 v217, v217
    v_mfma_f32_16x16x32_bf16 v[220:223], a[96:99], a[32:35], v[220:223]
    ds_read_b128 a[152:155], v240 offset:27648
    v_cvt_pk_bf16_f32 v44, v216, v217
    v_mfma_f32_16x16x32_bf16 v[224:227], a[96:99], a[64:67], v[200:203]
    v_exp_f32_e32 v218, v218
    v_mfma_f32_16x16x32_bf16 v[224:227], a[100:103], a[68:71], v[224:227]
    ds_read_b128 a[156:159], v241 offset:27648
    v_mfma_f32_16x16x32_bf16 v[224:227], a[104:107], a[72:75], v[224:227]
    v_exp_f32_e32 v219, v219
    v_mfma_f32_16x16x32_bf16 v[224:227], a[108:111], a[76:79], v[224:227]
    v_exp_f32_e32 v220, v220
    v_mfma_f32_16x16x32_bf16 v[224:227], a[112:115], a[80:83], v[224:227]
    v_exp_f32_e32 v221, v221
    v_mfma_f32_16x16x32_bf16 v[224:227], a[116:119], a[84:87], v[224:227]
    v_exp_f32_e32 v222, v222
    v_mfma_f32_16x16x32_bf16 v[224:227], a[120:123], a[88:91], v[224:227]
    buffer_load_dwordx4 v242, s[8:11], s26 offen offset:2048 nt lds
    v_mfma_f32_16x16x32_bf16 v[224:227], a[124:127], a[92:95], v[224:227]
    s_waitcnt vmcnt(11) lgkmcnt(0)
    v_exp_f32_e32 v223, v223
    v_mfma_f32_16x16x32_bf16 v[228:231], a[128:131], a[0:3], v[192:195]
    s_barrier
    v_cvt_pk_bf16_f32 v45, v218, v219
    v_mfma_f32_16x16x32_bf16 v[228:231], a[132:135], a[4:7], v[228:231]
    ds_read_b128 a[96:99], v240 offset:32768
    v_cvt_pk_bf16_f32 v108, v220, v221
    v_mfma_f32_16x16x32_bf16 v[228:231], a[136:139], a[8:11], v[228:231]
    v_exp_f32_e32 v224, v224
    v_mfma_f32_16x16x32_bf16 v[228:231], a[140:143], a[12:15], v[228:231]
    ds_read_b128 a[100:103], v241 offset:32768
    v_cvt_pk_bf16_f32 v109, v222, v223
    v_mfma_f32_16x16x32_bf16 v[228:231], a[144:147], a[16:19], v[228:231]
    v_exp_f32_e32 v225, v225
    v_mfma_f32_16x16x32_bf16 v[228:231], a[148:151], a[20:23], v[228:231]
    v_exp_f32_e32 v226, v226
    v_mfma_f32_16x16x32_bf16 v[228:231], a[152:155], a[24:27], v[228:231]
    ds_read_b128 a[104:107], v240 offset:33792
    v_cvt_pk_bf16_f32 v172, v224, v225
    v_mfma_f32_16x16x32_bf16 v[228:231], a[156:159], a[28:31], v[228:231]
    buffer_load_dwordx4 v242, s[8:11], s27 offen offset:3072 nt lds
    v_mfma_f32_16x16x32_bf16 v[232:235], a[156:159], a[60:63], v[196:199]
    ds_read_b128 a[108:111], v241 offset:33792
    v_mfma_f32_16x16x32_bf16 v[232:235], a[152:155], a[56:59], v[232:235]
    v_exp_f32_e32 v227, v227
    v_mfma_f32_16x16x32_bf16 v[232:235], a[148:151], a[52:55], v[232:235]
    s_add_u32 m0, s32, 98304
    v_cvt_pk_bf16_f32 v173, v226, v227
    v_mfma_f32_16x16x32_bf16 v[232:235], a[144:147], a[48:51], v[232:235]
    ds_read_b128 a[112:115], v240 offset:34816
    v_mfma_f32_16x16x32_bf16 v[232:235], a[140:143], a[44:47], v[232:235]
    v_exp_f32_e32 v228, v228
    v_mfma_f32_16x16x32_bf16 v[232:235], a[136:139], a[40:43], v[232:235]
    ds_read_b128 a[116:119], v241 offset:34816
    v_mfma_f32_16x16x32_bf16 v[232:235], a[132:135], a[36:39], v[232:235]
    v_exp_f32_e32 v229, v229
    v_mfma_f32_16x16x32_bf16 v[232:235], a[128:131], a[32:35], v[232:235]
    v_exp_f32_e32 v230, v230
    v_mfma_f32_16x16x32_bf16 v[236:239], a[128:131], a[64:67], v[200:203]
    ds_read_b128 a[120:123], v240 offset:35840
    v_cvt_pk_bf16_f32 v46, v228, v229
    v_mfma_f32_16x16x32_bf16 v[236:239], a[132:135], a[68:71], v[236:239]
    buffer_load_dwordx4 v243, s[12:15], 0 offen offset:0 nt lds
    v_mfma_f32_16x16x32_bf16 v[236:239], a[136:139], a[72:75], v[236:239]
    ds_read_b128 a[124:127], v241 offset:35840
    v_mfma_f32_16x16x32_bf16 v[236:239], a[140:143], a[76:79], v[236:239]
    v_exp_f32_e32 v231, v231
    v_mfma_f32_16x16x32_bf16 v[236:239], a[144:147], a[80:83], v[236:239]
    s_mov_b32 s38, 65920
    v_exp_f32_e32 v232, v232
    v_mfma_f32_16x16x32_bf16 v[236:239], a[148:151], a[84:87], v[236:239]
    v_exp_f32_e32 v233, v233
    v_mfma_f32_16x16x32_bf16 v[236:239], a[152:155], a[88:91], v[236:239]
    v_exp_f32_e32 v234, v234
    v_mfma_f32_16x16x32_bf16 v[236:239], a[156:159], a[92:95], v[236:239]
    s_waitcnt lgkmcnt(0)
    v_exp_f32_e32 v235, v235
    v_mfma_f32_16x16x32_bf16 v[204:207], a[96:99], a[0:3], v[192:195]
    ds_read_b128 a[128:131], v240 offset:40960
    v_cvt_pk_bf16_f32 v47, v230, v231
    v_mfma_f32_16x16x32_bf16 v[204:207], a[100:103], a[4:7], v[204:207]
    buffer_load_dwordx4 v243, s[12:15], s28 offen offset:1024 nt lds
    v_mfma_f32_16x16x32_bf16 v[204:207], a[104:107], a[8:11], v[204:207]
    ds_read_b128 a[132:135], v241 offset:40960
    v_cvt_pk_bf16_f32 v110, v232, v233
    v_mfma_f32_16x16x32_bf16 v[204:207], a[108:111], a[12:15], v[204:207]
    buffer_load_dword a240, v248, s[64:67], s38 offen
    v_mfma_f32_16x16x32_bf16 v[204:207], a[112:115], a[16:19], v[204:207]
    v_exp_f32_e32 v236, v236
    v_mfma_f32_16x16x32_bf16 v[204:207], a[116:119], a[20:23], v[204:207]
    ds_read_b128 a[136:139], v240 offset:41984
    v_cvt_pk_bf16_f32 v111, v234, v235
    v_mfma_f32_16x16x32_bf16 v[204:207], a[120:123], a[24:27], v[204:207]
    v_exp_f32_e32 v237, v237
    v_mfma_f32_16x16x32_bf16 v[204:207], a[124:127], a[28:31], v[204:207]
    ds_read_b128 a[140:143], v241 offset:41984
    v_cvt_pk_bf16_f32 v174, v236, v237
    v_mfma_f32_16x16x32_bf16 v[208:211], a[124:127], a[60:63], v[196:199]
    v_exp_f32_e32 v238, v238
    v_mfma_f32_16x16x32_bf16 v[208:211], a[120:123], a[56:59], v[208:211]
    v_exp_f32_e32 v239, v239
    v_mfma_f32_16x16x32_bf16 v[208:211], a[116:119], a[52:55], v[208:211]
    ds_read_b128 a[144:147], v240 offset:43008
    v_cvt_pk_bf16_f32 v175, v238, v239
    v_mfma_f32_16x16x32_bf16 v[208:211], a[112:115], a[48:51], v[208:211]
    buffer_load_dwordx4 v243, s[12:15], s29 offen offset:2048 nt lds
    v_mfma_f32_16x16x32_bf16 v[208:211], a[108:111], a[44:47], v[208:211]
    ds_read_b128 a[148:151], v241 offset:43008
    v_mfma_f32_16x16x32_bf16 v[208:211], a[104:107], a[40:43], v[208:211]
    v_exp_f32_e32 v204, v204
    v_mfma_f32_16x16x32_bf16 v[208:211], a[100:103], a[36:39], v[208:211]
    v_exp_f32_e32 v205, v205
    v_mfma_f32_16x16x32_bf16 v[208:211], a[96:99], a[32:35], v[208:211]
    ds_read_b128 a[152:155], v240 offset:44032
    v_cvt_pk_bf16_f32 v48, v204, v205
    v_mfma_f32_16x16x32_bf16 v[212:215], a[96:99], a[64:67], v[200:203]
    v_exp_f32_e32 v206, v206
    v_mfma_f32_16x16x32_bf16 v[212:215], a[100:103], a[68:71], v[212:215]
    ds_read_b128 a[156:159], v241 offset:44032
    v_mfma_f32_16x16x32_bf16 v[212:215], a[104:107], a[72:75], v[212:215]
    v_exp_f32_e32 v207, v207
    v_mfma_f32_16x16x32_bf16 v[212:215], a[108:111], a[76:79], v[212:215]
    buffer_load_dwordx4 v243, s[12:15], s30 offen offset:3072 nt lds
    v_mfma_f32_16x16x32_bf16 v[212:215], a[112:115], a[80:83], v[212:215]
    v_exp_f32_e32 v208, v208
    v_mfma_f32_16x16x32_bf16 v[212:215], a[116:119], a[84:87], v[212:215]
    v_exp_f32_e32 v209, v209
    v_mfma_f32_16x16x32_bf16 v[212:215], a[120:123], a[88:91], v[212:215]
    v_exp_f32_e32 v210, v210
    v_mfma_f32_16x16x32_bf16 v[212:215], a[124:127], a[92:95], v[212:215]
    s_waitcnt vmcnt(13) lgkmcnt(0)
    v_exp_f32_e32 v211, v211
    v_mfma_f32_16x16x32_bf16 v[216:219], a[128:131], a[0:3], v[192:195]
    s_barrier
    v_cvt_pk_bf16_f32 v49, v206, v207
    v_mfma_f32_16x16x32_bf16 v[216:219], a[132:135], a[4:7], v[216:219]
    s_add_u32 m0, s32, 114688
    ds_read_b128 a[96:99], v240 offset:49152
    v_cvt_pk_bf16_f32 v112, v208, v209
    v_mfma_f32_16x16x32_bf16 v[216:219], a[136:139], a[8:11], v[216:219]
    s_add_u32 s12, s12, 0x10000
    v_exp_f32_e32 v212, v212
    v_mfma_f32_16x16x32_bf16 v[216:219], a[140:143], a[12:15], v[216:219]
    s_addc_u32 s13, s13, 0
    ds_read_b128 a[100:103], v241 offset:49152
    v_cvt_pk_bf16_f32 v113, v210, v211
    v_mfma_f32_16x16x32_bf16 v[216:219], a[144:147], a[16:19], v[216:219]
    v_exp_f32_e32 v213, v213
    v_mfma_f32_16x16x32_bf16 v[216:219], a[148:151], a[20:23], v[216:219]
    v_exp_f32_e32 v214, v214
    v_mfma_f32_16x16x32_bf16 v[216:219], a[152:155], a[24:27], v[216:219]
    ds_read_b128 a[104:107], v240 offset:50176
    v_cvt_pk_bf16_f32 v176, v212, v213
    v_mfma_f32_16x16x32_bf16 v[216:219], a[156:159], a[28:31], v[216:219]
    buffer_load_dwordx4 v243, s[12:15], 0 offen offset:0 nt lds
    v_smfmac_f32_16x16x64_bf16 a[160:163], a[172:175], v[40:47], v253
    ds_read_b128 a[108:111], v241 offset:50176
    v_mfma_f32_16x16x32_bf16 v[220:223], a[156:159], a[60:63], v[196:199]
    v_exp_f32_e32 v215, v215
    v_mfma_f32_16x16x32_bf16 v[220:223], a[152:155], a[56:59], v[220:223]
    v_cvt_pk_bf16_f32 v177, v214, v215
    v_mfma_f32_16x16x32_bf16 v[220:223], a[148:151], a[52:55], v[220:223]
    ds_read_b128 a[112:115], v240 offset:51200
    v_mfma_f32_16x16x32_bf16 v[220:223], a[144:147], a[48:51], v[220:223]
    v_exp_f32_e32 v216, v216
    v_mfma_f32_16x16x32_bf16 v[220:223], a[140:143], a[44:47], v[220:223]
    ds_read_b128 a[116:119], v241 offset:51200
    v_mfma_f32_16x16x32_bf16 v[220:223], a[136:139], a[40:43], v[220:223]
    v_exp_f32_e32 v217, v217
    v_mfma_f32_16x16x32_bf16 v[220:223], a[132:135], a[36:39], v[220:223]
    buffer_load_dwordx4 v243, s[12:15], s28 offen offset:1024 nt lds
    v_mfma_f32_16x16x32_bf16 v[220:223], a[128:131], a[32:35], v[220:223]
    ds_read_b128 a[120:123], v240 offset:52224
    v_cvt_pk_bf16_f32 v50, v216, v217
    v_smfmac_f32_16x16x64_bf16 a[164:167], a[172:175], v[104:111], v253
    v_mfma_f32_16x16x32_bf16 v[224:227], a[128:131], a[64:67], v[200:203]
    ds_read_b128 a[124:127], v241 offset:52224
    v_mfma_f32_16x16x32_bf16 v[224:227], a[132:135], a[68:71], v[224:227]
    v_exp_f32_e32 v218, v218
    v_mfma_f32_16x16x32_bf16 v[224:227], a[136:139], a[72:75], v[224:227]
    v_exp_f32_e32 v219, v219
    v_mfma_f32_16x16x32_bf16 v[224:227], a[140:143], a[76:79], v[224:227]
    v_exp_f32_e32 v220, v220
    v_mfma_f32_16x16x32_bf16 v[224:227], a[144:147], a[80:83], v[224:227]
    v_exp_f32_e32 v221, v221
    v_mfma_f32_16x16x32_bf16 v[224:227], a[148:151], a[84:87], v[224:227]
    v_exp_f32_e32 v222, v222
    v_mfma_f32_16x16x32_bf16 v[224:227], a[152:155], a[88:91], v[224:227]
    buffer_load_dwordx4 v243, s[12:15], s29 offen offset:2048 nt lds
    v_mfma_f32_16x16x32_bf16 v[224:227], a[156:159], a[92:95], v[224:227]
    v_exp_f32_e32 v223, v223
    v_smfmac_f32_16x16x64_bf16 a[168:171], a[172:175], v[168:175], v253
    s_waitcnt lgkmcnt(0)
    v_cvt_pk_bf16_f32 v51, v218, v219
    v_mfma_f32_16x16x32_bf16 v[228:231], a[96:99], a[0:3], v[192:195]
    ds_read_b128 a[128:131], v240 offset:57344
    v_cvt_pk_bf16_f32 v114, v220, v221
    v_mfma_f32_16x16x32_bf16 v[228:231], a[100:103], a[4:7], v[228:231]
    v_exp_f32_e32 v224, v224
    v_mfma_f32_16x16x32_bf16 v[228:231], a[104:107], a[8:11], v[228:231]
    ds_read_b128 a[132:135], v241 offset:57344
    v_cvt_pk_bf16_f32 v115, v222, v223
    v_mfma_f32_16x16x32_bf16 v[228:231], a[108:111], a[12:15], v[228:231]
    v_exp_f32_e32 v225, v225
    v_mfma_f32_16x16x32_bf16 v[228:231], a[112:115], a[16:19], v[228:231]
    v_exp_f32_e32 v226, v226
    v_mfma_f32_16x16x32_bf16 v[228:231], a[116:119], a[20:23], v[228:231]
    ds_read_b128 a[136:139], v240 offset:58368
    v_cvt_pk_bf16_f32 v178, v224, v225
    v_mfma_f32_16x16x32_bf16 v[228:231], a[120:123], a[24:27], v[228:231]
    buffer_load_dwordx4 v243, s[12:15], s30 offen offset:3072 nt lds
    v_mfma_f32_16x16x32_bf16 v[228:231], a[124:127], a[28:31], v[228:231]
    ds_read_b128 a[140:143], v241 offset:58368
    v_mfma_f32_16x16x32_bf16 v[232:235], a[124:127], a[60:63], v[196:199]
    v_exp_f32_e32 v227, v227
    v_mfma_f32_16x16x32_bf16 v[232:235], a[120:123], a[56:59], v[232:235]
    v_cvt_pk_bf16_f32 v179, v226, v227
    v_mfma_f32_16x16x32_bf16 v[232:235], a[116:119], a[52:55], v[232:235]
    ds_read_b128 a[144:147], v240 offset:59392
    v_mfma_f32_16x16x32_bf16 v[232:235], a[112:115], a[48:51], v[232:235]
    v_exp_f32_e32 v228, v228
    v_mfma_f32_16x16x32_bf16 v[232:235], a[108:111], a[44:47], v[232:235]
    s_add_u32 m0, s32, 131072
    ds_read_b128 a[148:151], v241 offset:59392
    v_mfma_f32_16x16x32_bf16 v[232:235], a[104:107], a[40:43], v[232:235]
    s_add_u32 s12, s12, 0x10000
    v_exp_f32_e32 v229, v229
    v_mfma_f32_16x16x32_bf16 v[232:235], a[100:103], a[36:39], v[232:235]
    s_addc_u32 s13, s13, 0
    v_exp_f32_e32 v230, v230
    v_mfma_f32_16x16x32_bf16 v[232:235], a[96:99], a[32:35], v[232:235]
    ds_read_b128 a[152:155], v240 offset:60416
    v_cvt_pk_bf16_f32 v52, v228, v229
    v_mfma_f32_16x16x32_bf16 v[236:239], a[96:99], a[64:67], v[200:203]
    v_exp_f32_e32 v231, v231
    v_mfma_f32_16x16x32_bf16 v[236:239], a[100:103], a[68:71], v[236:239]
    ds_read_b128 a[156:159], v241 offset:60416
    v_cvt_pk_bf16_f32 v53, v230, v231
    v_mfma_f32_16x16x32_bf16 v[236:239], a[104:107], a[72:75], v[236:239]
    buffer_load_dwordx4 v243, s[12:15], 0 offen offset:0 nt lds
    v_mfma_f32_16x16x32_bf16 v[236:239], a[108:111], a[76:79], v[236:239]
    v_exp_f32_e32 v232, v232
    v_mfma_f32_16x16x32_bf16 v[236:239], a[112:115], a[80:83], v[236:239]
    v_exp_f32_e32 v233, v233
    v_mfma_f32_16x16x32_bf16 v[236:239], a[116:119], a[84:87], v[236:239]
    v_exp_f32_e32 v234, v234
    v_mfma_f32_16x16x32_bf16 v[236:239], a[120:123], a[88:91], v[236:239]
    v_xor_b32_e32 v240, 0x10000, v240
    v_cvt_pk_bf16_f32 v116, v232, v233
    v_mfma_f32_16x16x32_bf16 v[236:239], a[124:127], a[92:95], v[236:239]
    s_waitcnt vmcnt(14) lgkmcnt(0)
    v_xor_b32_e32 v241, 0x10000, v241
    v_mfma_f32_16x16x32_bf16 v[204:207], a[128:131], a[0:3], v[192:195]
    s_barrier
    v_mfma_f32_16x16x32_bf16 v[204:207], a[132:135], a[4:7], v[204:207]
    ds_read_b128 a[96:99], v240 offset:0
    v_mfma_f32_16x16x32_bf16 v[204:207], a[136:139], a[8:11], v[204:207]
    v_exp_f32_e32 v235, v235
    v_mfma_f32_16x16x32_bf16 v[204:207], a[140:143], a[12:15], v[204:207]
    ds_read_b128 a[100:103], v241 offset:0
    v_cvt_pk_bf16_f32 v117, v234, v235
    v_mfma_f32_16x16x32_bf16 v[204:207], a[144:147], a[16:19], v[204:207]
    buffer_load_dwordx4 v243, s[12:15], s28 offen offset:1024 nt lds
    v_mfma_f32_16x16x32_bf16 v[204:207], a[148:151], a[20:23], v[204:207]
    v_exp_f32_e32 v236, v236
    v_mfma_f32_16x16x32_bf16 v[204:207], a[152:155], a[24:27], v[204:207]
    ds_read_b128 a[104:107], v240 offset:1024
    v_mfma_f32_16x16x32_bf16 v[204:207], a[156:159], a[28:31], v[204:207]
    v_exp_f32_e32 v237, v237
    v_mfma_f32_16x16x32_bf16 v[208:211], a[156:159], a[60:63], v[196:199]
    ds_read_b128 a[108:111], v241 offset:1024
    v_cvt_pk_bf16_f32 v180, v236, v237
    v_mfma_f32_16x16x32_bf16 v[208:211], a[152:155], a[56:59], v[208:211]
    v_exp_f32_e32 v238, v238
    v_mfma_f32_16x16x32_bf16 v[208:211], a[148:151], a[52:55], v[208:211]
    v_exp_f32_e32 v239, v239
    v_mfma_f32_16x16x32_bf16 v[208:211], a[144:147], a[48:51], v[208:211]
    ds_read_b128 a[112:115], v240 offset:2048
    v_cvt_pk_bf16_f32 v181, v238, v239
    v_mfma_f32_16x16x32_bf16 v[208:211], a[140:143], a[44:47], v[208:211]
    buffer_load_dwordx4 v243, s[12:15], s29 offen offset:2048 nt lds
    v_mfma_f32_16x16x32_bf16 v[208:211], a[136:139], a[40:43], v[208:211]
    ds_read_b128 a[116:119], v241 offset:2048
    v_mfma_f32_16x16x32_bf16 v[208:211], a[132:135], a[36:39], v[208:211]
    v_exp_f32_e32 v204, v204
    v_mfma_f32_16x16x32_bf16 v[208:211], a[128:131], a[32:35], v[208:211]
    v_exp_f32_e32 v205, v205
    v_mfma_f32_16x16x32_bf16 v[212:215], a[128:131], a[64:67], v[200:203]
    ds_read_b128 a[120:123], v240 offset:3072
    v_cvt_pk_bf16_f32 v54, v204, v205
    v_mfma_f32_16x16x32_bf16 v[212:215], a[132:135], a[68:71], v[212:215]
L_pad3:
    s_cbranch_vccnz L_back
    v_exp_f32_e32 v206, v206
    v_mfma_f32_16x16x32_bf16 v[212:215], a[136:139], a[72:75], v[212:215]
    ds_read_b128 a[124:127], v241 offset:3072
    v_mfma_f32_16x16x32_bf16 v[212:215], a[140:143], a[76:79], v[212:215]
    v_exp_f32_e32 v207, v207
    v_mfma_f32_16x16x32_bf16 v[212:215], a[144:147], a[80:83], v[212:215]
    v_exp_f32_e32 v208, v208
    v_mfma_f32_16x16x32_bf16 v[212:215], a[148:151], a[84:87], v[212:215]
    buffer_load_dwordx4 v243, s[12:15], s30 offen offset:3072 nt lds
    v_mfma_f32_16x16x32_bf16 v[212:215], a[152:155], a[88:91], v[212:215]
    v_exp_f32_e32 v209, v209
    v_mfma_f32_16x16x32_bf16 v[212:215], a[156:159], a[92:95], v[212:215]
    s_waitcnt lgkmcnt(0)
    v_exp_f32_e32 v210, v210
    v_mfma_f32_16x16x32_bf16 v[216:219], a[96:99], a[0:3], v[192:195]
    s_add_u32 m0, s32, 147456
    ds_read_b128 a[128:131], v240 offset:8192
    v_cvt_pk_bf16_f32 v55, v206, v207
    v_mfma_f32_16x16x32_bf16 v[216:219], a[100:103], a[4:7], v[216:219]
    s_add_u32 s12, s12, 0x10000
    v_exp_f32_e32 v211, v211
    v_mfma_f32_16x16x32_bf16 v[216:219], a[104:107], a[8:11], v[216:219]
    s_addc_u32 s13, s13, 0
    ds_read_b128 a[132:135], v241 offset:8192
    v_cvt_pk_bf16_f32 v118, v208, v209
    v_mfma_f32_16x16x32_bf16 v[216:219], a[108:111], a[12:15], v[216:219]
    v_exp_f32_e32 v212, v212
    v_mfma_f32_16x16x32_bf16 v[216:219], a[112:115], a[16:19], v[216:219]
    v_exp_f32_e32 v213, v213
    v_mfma_f32_16x16x32_bf16 v[216:219], a[116:119], a[20:23], v[216:219]
    ds_read_b128 a[136:139], v240 offset:9216
    v_cvt_pk_bf16_f32 v119, v210, v211
    v_mfma_f32_16x16x32_bf16 v[216:219], a[120:123], a[24:27], v[216:219]
    buffer_load_dwordx4 v243, s[12:15], 0 offen offset:0 nt lds
    v_mfma_f32_16x16x32_bf16 v[216:219], a[124:127], a[28:31], v[216:219]
    ds_read_b128 a[140:143], v241 offset:9216
    v_cvt_pk_bf16_f32 v182, v212, v213
    v_mfma_f32_16x16x32_bf16 v[220:223], a[124:127], a[60:63], v[196:199]
    v_exp_f32_e32 v214, v214
    v_mfma_f32_16x16x32_bf16 v[220:223], a[120:123], a[56:59], v[220:223]
    v_exp_f32_e32 v215, v215
    v_mfma_f32_16x16x32_bf16 v[220:223], a[116:119], a[52:55], v[220:223]
    ds_read_b128 a[144:147], v240 offset:10240
    v_cvt_pk_bf16_f32 v183, v214, v215
    v_mfma_f32_16x16x32_bf16 v[220:223], a[112:115], a[48:51], v[220:223]
    v_exp_f32_e32 v216, v216
    v_mfma_f32_16x16x32_bf16 v[220:223], a[108:111], a[44:47], v[220:223]
    ds_read_b128 a[148:151], v241 offset:10240
    v_mfma_f32_16x16x32_bf16 v[220:223], a[104:107], a[40:43], v[220:223]
    v_exp_f32_e32 v217, v217
    v_mfma_f32_16x16x32_bf16 v[220:223], a[100:103], a[36:39], v[220:223]
    v_exp_f32_e32 v218, v218
    v_mfma_f32_16x16x32_bf16 v[220:223], a[96:99], a[32:35], v[220:223]
    ds_read_b128 a[152:155], v240 offset:11264
    v_cvt_pk_bf16_f32 v56, v216, v217
    v_mfma_f32_16x16x32_bf16 v[224:227], a[96:99], a[64:67], v[200:203]
    buffer_load_dwordx4 v243, s[12:15], s28 offen offset:1024 nt lds
    v_mfma_f32_16x16x32_bf16 v[224:227], a[100:103], a[68:71], v[224:227]
    ds_read_b128 a[156:159], v241 offset:11264
    v_mfma_f32_16x16x32_bf16 v[224:227], a[104:107], a[72:75], v[224:227]
    v_exp_f32_e32 v219, v219
    v_mfma_f32_16x16x32_bf16 v[224:227], a[108:111], a[76:79], v[224:227]
    v_exp_f32_e32 v220, v220
    v_mfma_f32_16x16x32_bf16 v[224:227], a[112:115], a[80:83], v[224:227]
    s_mov_b32 s38, 70016
    v_exp_f32_e32 v221, v221
    v_mfma_f32_16x16x32_bf16 v[224:227], a[116:119], a[84:87], v[224:227]
    v_exp_f32_e32 v222, v222
    v_mfma_f32_16x16x32_bf16 v[224:227], a[120:123], a[88:91], v[224:227]
    v_exp_f32_e32 v223, v223
    v_mfma_f32_16x16x32_bf16 v[224:227], a[124:127], a[92:95], v[224:227]
    s_waitcnt vmcnt(15) lgkmcnt(0)
    v_cvt_pk_bf16_f32 v57, v218, v219
    v_cvt_pk_bf16_f32 v120, v220, v221
    v_mfma_f32_16x16x32_bf16 v[228:231], a[128:131], a[0:3], v[192:195]
    s_barrier
    v_cvt_pk_bf16_f32 v121, v222, v223
    v_mfma_f32_16x16x32_bf16 v[228:231], a[132:135], a[4:7], v[228:231]
    ds_read_b128 a[96:99], v240 offset:16384
    v_mfma_f32_16x16x32_bf16 v[228:231], a[136:139], a[8:11], v[228:231]
    buffer_load_dwordx4 v243, s[12:15], s29 offen offset:2048 nt lds
    v_mfma_f32_16x16x32_bf16 v[228:231], a[140:143], a[12:15], v[228:231]
    ds_read_b128 a[100:103], v241 offset:16384
    v_mfma_f32_16x16x32_bf16 v[228:231], a[144:147], a[16:19], v[228:231]
    buffer_load_dword a241, v248, s[64:67], s38 offen
    v_mfma_f32_16x16x32_bf16 v[228:231], a[148:151], a[20:23], v[228:231]
    v_exp_f32_e32 v224, v224
    v_mfma_f32_16x16x32_bf16 v[228:231], a[152:155], a[24:27], v[228:231]
    ds_read_b128 a[104:107], v240 offset:17408
    v_mfma_f32_16x16x32_bf16 v[228:231], a[156:159], a[28:31], v[228:231]
    v_exp_f32_e32 v225, v225
    v_smfmac_f32_16x16x64_bf16 a[160:163], a[172:175], v[48:55], v253
    ds_read_b128 a[108:111], v241 offset:17408
    v_mfma_f32_16x16x32_bf16 v[232:235], a[156:159], a[60:63], v[196:199]
    buffer_load_dwordx4 v243, s[12:15], s30 offen offset:3072 nt lds
    v_mfma_f32_16x16x32_bf16 v[232:235], a[152:155], a[56:59], v[232:235]
    v_exp_f32_e32 v226, v226
    v_mfma_f32_16x16x32_bf16 v[232:235], a[148:151], a[52:55], v[232:235]
    ds_read_b128 a[112:115], v240 offset:18432
    v_cvt_pk_bf16_f32 v184, v224, v225
    v_mfma_f32_16x16x32_bf16 v[232:235], a[144:147], a[48:51], v[232:235]
    v_exp_f32_e32 v227, v227
    v_mfma_f32_16x16x32_bf16 v[232:235], a[140:143], a[44:47], v[232:235]
    ds_read_b128 a[116:119], v241 offset:18432
    v_cvt_pk_bf16_f32 v185, v226, v227
    v_mfma_f32_16x16x32_bf16 v[232:235], a[136:139], a[40:43], v[232:235]
    v_exp_f32_e32 v228, v228
    v_mfma_f32_16x16x32_bf16 v[232:235], a[132:135], a[36:39], v[232:235]
    s_mov_b32 m0, s32
    v_exp_f32_e32 v229, v229
    v_mfma_f32_16x16x32_bf16 v[232:235], a[128:131], a[32:35], v[232:235]
    s_sub_u32 s12, s12, 196480
    ds_read_b128 a[120:123], v240 offset:19456
    v_cvt_pk_bf16_f32 v58, v228, v229
    v_smfmac_f32_16x16x64_bf16 a[164:167], a[172:175], v[112:119], v253
    s_subb_u32 s13, s13, 0
    v_mfma_f32_16x16x32_bf16 v[236:239], a[128:131], a[64:67], v[200:203]
    ds_read_b128 a[124:127], v241 offset:19456
    v_mfma_f32_16x16x32_bf16 v[236:239], a[132:135], a[68:71], v[236:239]
    v_exp_f32_e32 v230, v230
    v_mfma_f32_16x16x32_bf16 v[236:239], a[136:139], a[72:75], v[236:239]
    v_exp_f32_e32 v231, v231
    v_mfma_f32_16x16x32_bf16 v[236:239], a[140:143], a[76:79], v[236:239]
    buffer_load_dwordx4 v243, s[12:15], 0 offen offset:0 nt lds
    v_mfma_f32_16x16x32_bf16 v[236:239], a[144:147], a[80:83], v[236:239]
    v_exp_f32_e32 v232, v232
    v_mfma_f32_16x16x32_bf16 v[236:239], a[148:151], a[84:87], v[236:239]
    v_exp_f32_e32 v233, v233
    v_mfma_f32_16x16x32_bf16 v[236:239], a[152:155], a[88:91], v[236:239]
    v_exp_f32_e32 v234, v234
    v_mfma_f32_16x16x32_bf16 v[236:239], a[156:159], a[92:95], v[236:239]
    v_exp_f32_e32 v235, v235
    v_smfmac_f32_16x16x64_bf16 a[168:171], a[172:175], v[176:183], v253
    s_waitcnt lgkmcnt(0)
    v_cvt_pk_bf16_f32 v59, v230, v231
    v_mfma_f32_16x16x32_bf16 v[204:207], a[96:99], a[0:3], v[192:195]
    ds_read_b128 a[128:131], v240 offset:24576
    v_cvt_pk_bf16_f32 v122, v232, v233
    v_mfma_f32_16x16x32_bf16 v[204:207], a[100:103], a[4:7], v[204:207]
    v_exp_f32_e32 v236, v236
    v_mfma_f32_16x16x32_bf16 v[204:207], a[104:107], a[8:11], v[204:207]
    ds_read_b128 a[132:135], v241 offset:24576
    v_cvt_pk_bf16_f32 v123, v234, v235
    v_mfma_f32_16x16x32_bf16 v[204:207], a[108:111], a[12:15], v[204:207]
    buffer_load_dwordx4 v243, s[12:15], s28 offen offset:1024 nt lds
    v_mfma_f32_16x16x32_bf16 v[204:207], a[112:115], a[16:19], v[204:207]
    v_exp_f32_e32 v237, v237
    v_mfma_f32_16x16x32_bf16 v[204:207], a[116:119], a[20:23], v[204:207]
    ds_read_b128 a[136:139], v240 offset:25600
    v_cvt_pk_bf16_f32 v186, v236, v237
    v_mfma_f32_16x16x32_bf16 v[204:207], a[120:123], a[24:27], v[204:207]
    v_exp_f32_e32 v238, v238
    v_mfma_f32_16x16x32_bf16 v[204:207], a[124:127], a[28:31], v[204:207]
    ds_read_b128 a[140:143], v241 offset:25600
    v_mfma_f32_16x16x32_bf16 v[208:211], a[124:127], a[60:63], v[196:199]
    v_exp_f32_e32 v239, v239
    v_mfma_f32_16x16x32_bf16 v[208:211], a[120:123], a[56:59], v[208:211]
    v_cvt_pk_bf16_f32 v187, v238, v239
    v_mfma_f32_16x16x32_bf16 v[208:211], a[116:119], a[52:55], v[208:211]
    ds_read_b128 a[144:147], v240 offset:26624
    v_mfma_f32_16x16x32_bf16 v[208:211], a[112:115], a[48:51], v[208:211]
    v_exp_f32_e32 v204, v204
    v_mfma_f32_16x16x32_bf16 v[208:211], a[108:111], a[44:47], v[208:211]
    ds_read_b128 a[148:151], v241 offset:26624
    v_mfma_f32_16x16x32_bf16 v[208:211], a[104:107], a[40:43], v[208:211]
    buffer_load_dwordx4 v243, s[12:15], s29 offen offset:2048 nt lds
    v_mfma_f32_16x16x32_bf16 v[208:211], a[100:103], a[36:39], v[208:211]
    v_exp_f32_e32 v205, v205
    v_mfma_f32_16x16x32_bf16 v[208:211], a[96:99], a[32:35], v[208:211]
    ds_read_b128 a[152:155], v240 offset:27648
    v_cvt_pk_bf16_f32 v60, v204, v205
    v_mfma_f32_16x16x32_bf16 v[212:215], a[96:99], a[64:67], v[200:203]
    v_exp_f32_e32 v206, v206
    v_mfma_f32_16x16x32_bf16 v[212:215], a[100:103], a[68:71], v[212:215]
    ds_read_b128 a[156:159], v241 offset:27648
    v_mfma_f32_16x16x32_bf16 v[212:215], a[104:107], a[72:75], v[212:215]
    v_exp_f32_e32 v207, v207
    v_mfma_f32_16x16x32_bf16 v[212:215], a[108:111], a[76:79], v[212:215]
    v_exp_f32_e32 v208, v208
    v_mfma_f32_16x16x32_bf16 v[212:215], a[112:115], a[80:83], v[212:215]
    v_exp_f32_e32 v209, v209
    v_mfma_f32_16x16x32_bf16 v[212:215], a[116:119], a[84:87], v[212:215]
    buffer_load_dwordx4 v243, s[12:15], s30 offen offset:3072 nt lds
    v_mfma_f32_16x16x32_bf16 v[212:215], a[120:123], a[88:91], v[212:215]
    v_exp_f32_e32 v210, v210
    v_mfma_f32_16x16x32_bf16 v[212:215], a[124:127], a[92:95], v[212:215]
    s_waitcnt vmcnt(13) lgkmcnt(0)
    v_exp_f32_e32 v211, v211
    v_mfma_f32_16x16x32_bf16 v[216:219], a[128:131], a[0:3], v[192:195]
    s_barrier
    v_cvt_pk_bf16_f32 v61, v206, v207
    v_mfma_f32_16x16x32_bf16 v[216:219], a[132:135], a[4:7], v[216:219]
    s_add_u32 m0, s32, 16384
    ds_read_b64_tr_b16 a[96:97], v244 offset:0
    v_cvt_pk_bf16_f32 v124, v208, v209
    v_mfma_f32_16x16x32_bf16 v[216:219], a[136:139], a[8:11], v[216:219]
    s_add_u32 s12, s12, 0x10000
    ds_read_b64_tr_b16 a[98:99], v244 offset:2048
    v_cvt_pk_bf16_f32 v125, v210, v211
    v_mfma_f32_16x16x32_bf16 v[216:219], a[140:143], a[12:15], v[216:219]
    s_addc_u32 s13, s13, 0
    ds_read_b64_tr_b16 a[100:101], v244 offset:4096
    v_mfma_f32_16x16x32_bf16 v[216:219], a[144:147], a[16:19], v[216:219]
    ds_read_b64_tr_b16 a[102:103], v244 offset:6144
    v_mfma_f32_16x16x32_bf16 v[216:219], a[148:151], a[20:23], v[216:219]
    v_exp_f32_e32 v212, v212
    v_mfma_f32_16x16x32_bf16 v[216:219], a[152:155], a[24:27], v[216:219]
    ds_read_b64_tr_b16 a[104:105], v244 offset:8192
    v_mfma_f32_16x16x32_bf16 v[216:219], a[156:159], a[28:31], v[216:219]
    ds_read_b64_tr_b16 a[106:107], v244 offset:10240
    v_mfma_f32_16x16x32_bf16 v[220:223], a[156:159], a[60:63], v[196:199]
    ds_read_b64_tr_b16 a[108:109], v244 offset:12288
    v_mfma_f32_16x16x32_bf16 v[220:223], a[152:155], a[56:59], v[220:223]
    ds_read_b64_tr_b16 a[110:111], v244 offset:14336
    v_mfma_f32_16x16x32_bf16 v[220:223], a[148:151], a[52:55], v[220:223]
    buffer_load_dwordx4 v243, s[12:15], 0 offen offset:0 nt lds
    v_mfma_f32_16x16x32_bf16 v[220:223], a[144:147], a[48:51], v[220:223]
    ds_read_b64_tr_b16 a[112:113], v244 offset:16384
    v_mfma_f32_16x16x32_bf16 v[220:223], a[140:143], a[44:47], v[220:223]
    ds_read_b64_tr_b16 a[114:115], v244 offset:18432
    v_mfma_f32_16x16x32_bf16 v[220:223], a[136:139], a[40:43], v[220:223]
    ds_read_b64_tr_b16 a[116:117], v244 offset:20480
    v_mfma_f32_16x16x32_bf16 v[220:223], a[132:135], a[36:39], v[220:223]
    ds_read_b64_tr_b16 a[118:119], v244 offset:22528
    v_mfma_f32_16x16x32_bf16 v[220:223], a[128:131], a[32:35], v[220:223]
    v_exp_f32_e32 v213, v213
    v_mfma_f32_16x16x32_bf16 v[224:227], a[128:131], a[64:67], v[200:203]
    ds_read_b64_tr_b16 a[120:121], v244 offset:24576
    v_exp_f32_e32 v214, v214
    v_mfma_f32_16x16x32_bf16 v[224:227], a[132:135], a[68:71], v[224:227]
    ds_read_b64_tr_b16 a[122:123], v244 offset:26624
    v_exp_f32_e32 v215, v215
    v_mfma_f32_16x16x32_bf16 v[224:227], a[136:139], a[72:75], v[224:227]
    ds_read_b64_tr_b16 a[124:125], v244 offset:28672
    v_exp_f32_e32 v216, v216
    v_mfma_f32_16x16x32_bf16 v[224:227], a[140:143], a[76:79], v[224:227]
    ds_read_b64_tr_b16 a[126:127], v244 offset:30720
    v_exp_f32_e32 v217, v217
    v_mfma_f32_16x16x32_bf16 v[224:227], a[144:147], a[80:83], v[224:227]
    buffer_load_dwordx4 v243, s[12:15], s28 offen offset:1024 nt lds
    v_mfma_f32_16x16x32_bf16 v[224:227], a[148:151], a[84:87], v[224:227]
    v_exp_f32_e32 v218, v218
    v_mfma_f32_16x16x32_bf16 v[224:227], a[152:155], a[88:91], v[224:227]
    v_exp_f32_e32 v219, v219
    v_mfma_f32_16x16x32_bf16 v[224:227], a[156:159], a[92:95], v[224:227]
    s_waitcnt lgkmcnt(0)
    v_xor_b32_e32 v244, 0x20, v244
    v_cvt_pk_bf16_f32 v188, v212, v213
    v_mfma_f32_16x16x32_bf16 v[192:195], a[96:99], v[0:3], 0
    v_exp_f32_e32 v220, v220
    v_cvt_pk_bf16_f32 v189, v214, v215
    v_mfma_f32_16x16x32_bf16 v[192:195], a[100:103], v[4:7], v[192:195]
    ds_read_b64_tr_b16 a[128:129], v244 offset:0
    v_exp_f32_e32 v221, v221
    v_mfma_f32_16x16x32_bf16 v[192:195], a[104:107], v[8:11], v[192:195]
    ds_read_b64_tr_b16 a[130:131], v244 offset:2048
    v_cvt_pk_bf16_f32 v62, v216, v217
    v_mfma_f32_16x16x32_bf16 v[192:195], a[108:111], v[12:15], v[192:195]
    ds_read_b64_tr_b16 a[132:133], v244 offset:4096
    v_cvt_pk_bf16_f32 v63, v218, v219
    v_mfma_f32_16x16x32_bf16 v[192:195], a[112:115], v[16:19], v[192:195]
    ds_read_b64_tr_b16 a[134:135], v244 offset:6144
    v_cvt_pk_bf16_f32 v126, v220, v221
    v_mfma_f32_16x16x32_bf16 v[192:195], a[116:119], v[20:23], v[192:195]
    buffer_load_dwordx4 v243, s[12:15], s29 offen offset:2048 nt lds
    v_mfma_f32_16x16x32_bf16 v[192:195], a[120:123], v[24:27], v[192:195]
    ds_read_b64_tr_b16 a[136:137], v244 offset:8192
    v_mfma_f32_16x16x32_bf16 v[192:195], a[124:127], v[28:31], v[192:195]
    ds_read_b64_tr_b16 a[138:139], v244 offset:10240
    v_mfma_f32_16x16x32_bf16 v[196:199], a[124:127], v[92:95], 0
    ds_read_b64_tr_b16 a[140:141], v244 offset:12288
    v_mfma_f32_16x16x32_bf16 v[196:199], a[120:123], v[88:91], v[196:199]
    ds_read_b64_tr_b16 a[142:143], v244 offset:14336
    v_mfma_f32_16x16x32_bf16 v[196:199], a[116:119], v[84:87], v[196:199]
    buffer_load_dwordx4 v243, s[12:15], s30 offen offset:3072 nt lds
    v_mfma_f32_16x16x32_bf16 v[196:199], a[112:115], v[80:83], v[196:199]
    ds_read_b64_tr_b16 a[144:145], v244 offset:16384
    v_mfma_f32_16x16x32_bf16 v[196:199], a[108:111], v[76:79], v[196:199]
    ds_read_b64_tr_b16 a[146:147], v244 offset:18432
    v_mfma_f32_16x16x32_bf16 v[196:199], a[104:107], v[72:75], v[196:199]
    ds_read_b64_tr_b16 a[148:149], v244 offset:20480
    v_mfma_f32_16x16x32_bf16 v[196:199], a[100:103], v[68:71], v[196:199]
    s_add_u32 m0, s32, 32768
    ds_read_b64_tr_b16 a[150:151], v244 offset:22528
    v_mfma_f32_16x16x32_bf16 v[196:199], a[96:99], v[64:67], v[196:199]
    s_add_u32 s12, s12, 0x10000
    v_exp_f32_e32 v222, v222
    v_mfma_f32_16x16x32_bf16 v[200:203], a[96:99], v[128:131], 0
    s_addc_u32 s13, s13, 0
    ds_read_b64_tr_b16 a[152:153], v244 offset:24576
    v_mfma_f32_16x16x32_bf16 v[200:203], a[100:103], v[132:135], v[200:203]
    ds_read_b64_tr_b16 a[154:155], v244 offset:26624
    v_mfma_f32_16x16x32_bf16 v[200:203], a[104:107], v[136:139], v[200:203]
    ds_read_b64_tr_b16 a[156:157], v244 offset:28672
    v_mfma_f32_16x16x32_bf16 v[200:203], a[108:111], v[140:143], v[200:203]
    ds_read_b64_tr_b16 a[158:159], v244 offset:30720
    v_mfma_f32_16x16x32_bf16 v[200:203], a[112:115], v[144:147], v[200:203]
    buffer_load_dwordx4 v243, s[12:15], 0 offen offset:0 nt lds
    v_mfma_f32_16x16x32_bf16 v[200:203], a[116:119], v[148:151], v[200:203]
    s_mov_b32 s38, 131456
    v_exp_f32_e32 v223, v223
    v_mfma_f32_16x16x32_bf16 v[200:203], a[120:123], v[152:155], v[200:203]
    v_exp_f32_e32 v224, v224
    v_mfma_f32_16x16x32_bf16 v[200:203], a[124:127], v[156:159], v[200:203]
    s_waitcnt lgkmcnt(0)
    v_xor_b32_e32 v244, 0x60, v244
    v_cvt_pk_bf16_f32 v127, v222, v223
    v_mfma_f32_16x16x32_bf16 v[204:207], a[128:131], v[0:3], 0
    buffer_load_dword a242, v248, s[64:67], s38 offen
    v_mfma_f32_16x16x32_bf16 v[204:207], a[132:135], v[4:7], v[204:207]
    ds_read_b64_tr_b16 a[96:97], v244 offset:0
    v_mfma_f32_16x16x32_bf16 v[204:207], a[136:139], v[8:11], v[204:207]
    ds_read_b64_tr_b16 a[98:99], v244 offset:2048
    v_mfma_f32_16x16x32_bf16 v[204:207], a[140:143], v[12:15], v[204:207]
    ds_read_b64_tr_b16 a[100:101], v244 offset:4096
    v_mfma_f32_16x16x32_bf16 v[204:207], a[144:147], v[16:19], v[204:207]
    ds_read_b64_tr_b16 a[102:103], v244 offset:6144
    v_mfma_f32_16x16x32_bf16 v[204:207], a[148:151], v[20:23], v[204:207]
    buffer_load_dwordx4 v243, s[12:15], s28 offen offset:1024 nt lds
    v_mfma_f32_16x16x32_bf16 v[204:207], a[152:155], v[24:27], v[204:207]
    ds_read_b64_tr_b16 a[104:105], v244 offset:8192
    v_mfma_f32_16x16x32_bf16 v[204:207], a[156:159], v[28:31], v[204:207]
    ds_read_b64_tr_b16 a[106:107], v244 offset:10240
    v_smfmac_f32_16x16x64_bf16 a[160:163], a[172:175], v[56:63], v253
    ds_read_b64_tr_b16 a[108:109], v244 offset:12288
    v_mfma_f32_16x16x32_bf16 v[208:211], a[156:159], v[92:95], 0
    ds_read_b64_tr_b16 a[110:111], v244 offset:14336
    v_mfma_f32_16x16x32_bf16 v[208:211], a[152:155], v[88:91], v[208:211]
    v_exp_f32_e32 v225, v225
    v_mfma_f32_16x16x32_bf16 v[208:211], a[148:151], v[84:87], v[208:211]
    ds_read_b64_tr_b16 a[112:113], v244 offset:16384
    v_cvt_pk_bf16_f32 v190, v224, v225
    v_mfma_f32_16x16x32_bf16 v[208:211], a[144:147], v[80:83], v[208:211]
    ds_read_b64_tr_b16 a[114:115], v244 offset:18432
    v_mfma_f32_16x16x32_bf16 v[208:211], a[140:143], v[76:79], v[208:211]
    ds_read_b64_tr_b16 a[116:117], v244 offset:20480
    v_mfma_f32_16x16x32_bf16 v[208:211], a[136:139], v[72:75], v[208:211]
    ds_read_b64_tr_b16 a[118:119], v244 offset:22528
    v_mfma_f32_16x16x32_bf16 v[208:211], a[132:135], v[68:71], v[208:211]
    buffer_load_dwordx4 v243, s[12:15], s29 offen offset:2048 nt lds
    v_mfma_f32_16x16x32_bf16 v[208:211], a[128:131], v[64:67], v[208:211]
    ds_read_b64_tr_b16 a[120:121], v244 offset:24576
    v_smfmac_f32_16x16x64_bf16 a[164:167], a[172:175], v[120:127], v253
    ds_read_b64_tr_b16 a[122:123], v244 offset:26624
    v_mfma_f32_16x16x32_bf16 v[212:215], a[128:131], v[128:131], 0
    ds_read_b64_tr_b16 a[124:125], v244 offset:28672
    v_mfma_f32_16x16x32_bf16 v[212:215], a[132:135], v[132:135], v[212:215]
    ds_read_b64_tr_b16 a[126:127], v244 offset:30720
    v_mfma_f32_16x16x32_bf16 v[212:215], a[136:139], v[136:139], v[212:215]
    v_exp_f32_e32 v226, v226
    v_mfma_f32_16x16x32_bf16 v[212:215], a[140:143], v[140:143], v[212:215]
    v_exp_f32_e32 v227, v227
    v_mfma_f32_16x16x32_bf16 v[212:215], a[144:147], v[144:147], v[212:215]
    v_cvt_pk_bf16_f32 v191, v226, v227
    v_mfma_f32_16x16x32_bf16 v[212:215], a[148:151], v[148:151], v[212:215]
    buffer_load_dwordx4 v243, s[12:15], s30 offen offset:3072 nt lds
    v_mfma_f32_16x16x32_bf16 v[212:215], a[152:155], v[152:155], v[212:215]
    v_mfma_f32_16x16x32_bf16 v[212:215], a[156:159], v[156:159], v[212:215]
    v_smfmac_f32_16x16x64_bf16 a[168:171], a[172:175], v[184:191], v253
    s_waitcnt lgkmcnt(0)
    v_xor_b32_e32 v244, 0x20, v244
    v_mfma_f32_16x16x32_bf16 v[216:219], a[96:99], v[0:3], 0
    v_mov_b32_e32 v255, s35
    v_mfma_f32_16x16x32_bf16 v[216:219], a[100:103], v[4:7], v[216:219]
    ds_read_b64_tr_b16 a[128:129], v244 offset:0
    v_mfma_f32_16x16x32_bf16 v[216:219], a[104:107], v[8:11], v[216:219]
    s_add_u32 m0, s32, 49152
    ds_read_b64_tr_b16 a[130:131], v244 offset:2048
    v_accvgpr_read_b32 v251, a160
    v_mfma_f32_16x16x32_bf16 v[216:219], a[108:111], v[12:15], v[216:219]
    s_add_u32 s12, s12, 0x10000
    ds_read_b64_tr_b16 a[132:133], v244 offset:4096
    v_accvgpr_read_b32 v252, a164
    v_mfma_f32_16x16x32_bf16 v[216:219], a[112:115], v[16:19], v[216:219]
    s_addc_u32 s13, s13, 0
    ds_read_b64_tr_b16 a[134:135], v244 offset:6144
    v_accvgpr_read_b32 v253, a168
    v_mfma_f32_16x16x32_bf16 v[216:219], a[116:119], v[20:23], v[216:219]
    v_accvgpr_read_b32 v254, a161
    v_add_f32_e32 v251, v251, v254
    v_mfma_f32_16x16x32_bf16 v[216:219], a[120:123], v[24:27], v[216:219]
    ds_read_b64_tr_b16 a[136:137], v244 offset:8192
    v_accvgpr_read_b32 v254, a165
    v_mfma_f32_16x16x32_bf16 v[216:219], a[124:127], v[28:31], v[216:219]
    ds_read_b64_tr_b16 a[138:139], v244 offset:10240
    v_add_f32_e32 v252, v252, v254
    v_mfma_f32_16x16x32_bf16 v[220:223], a[124:127], v[92:95], 0
    ds_read_b64_tr_b16 a[140:141], v244 offset:12288
    v_accvgpr_read_b32 v254, a169
    v_mfma_f32_16x16x32_bf16 v[220:223], a[120:123], v[88:91], v[220:223]
    ds_read_b64_tr_b16 a[142:143], v244 offset:14336
    v_add_f32_e32 v253, v253, v254
    v_mfma_f32_16x16x32_bf16 v[220:223], a[116:119], v[84:87], v[220:223]
    buffer_load_dwordx4 v243, s[12:15], 0 offen offset:0 nt lds
    v_mfma_f32_16x16x32_bf16 v[220:223], a[112:115], v[80:83], v[220:223]
    ds_read_b64_tr_b16 a[144:145], v244 offset:16384
    v_max3_f32 v254, v251, v252, v253
    v_mfma_f32_16x16x32_bf16 v[220:223], a[108:111], v[76:79], v[220:223]
    ds_read_b64_tr_b16 a[146:147], v244 offset:18432
    v_cmp_nlt_f32_e64 s[48:49], v254, s47
    v_mfma_f32_16x16x32_bf16 v[220:223], a[104:107], v[72:75], v[220:223]
    ds_read_b64_tr_b16 a[148:149], v244 offset:20480
    v_mfma_f32_16x16x32_bf16 v[220:223], a[100:103], v[68:71], v[220:223]
    ds_read_b64_tr_b16 a[150:151], v244 offset:22528
    v_mov_b32_e32 v254, s48
    v_mfma_f32_16x16x32_bf16 v[220:223], a[96:99], v[64:67], v[220:223]
    v_rcp_f32_e32 v251, v251
    v_mfma_f32_16x16x32_bf16 v[224:227], a[96:99], v[128:131], 0
    ds_read_b64_tr_b16 a[152:153], v244 offset:24576
    v_or_b32_e32 v254, s49, v254
    v_mfma_f32_16x16x32_bf16 v[224:227], a[100:103], v[132:135], v[224:227]
    ds_read_b64_tr_b16 a[154:155], v244 offset:26624
    v_mfma_f32_16x16x32_bf16 v[224:227], a[104:107], v[136:139], v[224:227]
    ds_read_b64_tr_b16 a[156:157], v244 offset:28672
    v_mfma_f32_16x16x32_bf16 v[224:227], a[108:111], v[140:143], v[224:227]
    ds_read_b64_tr_b16 a[158:159], v244 offset:30720
    v_mfma_f32_16x16x32_bf16 v[224:227], a[112:115], v[144:147], v[224:227]
    buffer_load_dwordx4 v243, s[12:15], s28 offen offset:1024 nt lds
    v_mfma_f32_16x16x32_bf16 v[224:227], a[116:119], v[148:151], v[224:227]
    v_rcp_f32_e32 v252, v252
    v_mfma_f32_16x16x32_bf16 v[224:227], a[120:123], v[152:155], v[224:227]
    v_rcp_f32_e32 v253, v253
    v_mfma_f32_16x16x32_bf16 v[224:227], a[124:127], v[156:159], v[224:227]
    s_waitcnt vmcnt(15) lgkmcnt(0)
    v_xor_b32_e32 v244, 0x38060, v244
    v_mfma_f32_16x16x32_bf16 v[228:231], a[128:131], v[0:3], 0
    s_barrier
    v_mfma_f32_16x16x32_bf16 v[228:231], a[132:135], v[4:7], v[228:231]
    ds_read_b64_tr_b16 a[96:97], v244 offset:0
    v_mfma_f32_16x16x32_bf16 v[228:231], a[136:139], v[8:11], v[228:231]
    ds_read_b64_tr_b16 a[98:99], v244 offset:2048
    v_mfma_f32_16x16x32_bf16 v[228:231], a[140:143], v[12:15], v[228:231]
    ds_read_b64_tr_b16 a[100:101], v244 offset:4096
    v_mfma_f32_16x16x32_bf16 v[228:231], a[144:147], v[16:19], v[228:231]
    ds_read_b64_tr_b16 a[102:103], v244 offset:6144
    v_mfma_f32_16x16x32_bf16 v[228:231], a[148:151], v[20:23], v[228:231]
    buffer_load_dwordx4 v243, s[12:15], s29 offen offset:2048 nt lds
    v_mfma_f32_16x16x32_bf16 v[228:231], a[152:155], v[24:27], v[228:231]
    ds_read_b64_tr_b16 a[104:105], v244 offset:8192
    v_mfma_f32_16x16x32_bf16 v[228:231], a[156:159], v[28:31], v[228:231]
    ds_read_b64_tr_b16 a[106:107], v244 offset:10240
    v_mfma_f32_16x16x32_bf16 v[232:235], a[156:159], v[92:95], 0
    ds_read_b64_tr_b16 a[108:109], v244 offset:12288
    v_mfma_f32_16x16x32_bf16 v[232:235], a[152:155], v[88:91], v[232:235]
    ds_read_b64_tr_b16 a[110:111], v244 offset:14336
    v_mfma_f32_16x16x32_bf16 v[232:235], a[148:151], v[84:87], v[232:235]
    v_mfma_f32_16x16x32_bf16 v[232:235], a[144:147], v[80:83], v[232:235]
    ds_read_b64_tr_b16 a[112:113], v244 offset:16384
    v_mfma_f32_16x16x32_bf16 v[232:235], a[140:143], v[76:79], v[232:235]
    ds_read_b64_tr_b16 a[114:115], v244 offset:18432
    v_mfma_f32_16x16x32_bf16 v[232:235], a[136:139], v[72:75], v[232:235]
    ds_read_b64_tr_b16 a[116:117], v244 offset:20480
    v_mfma_f32_16x16x32_bf16 v[232:235], a[132:135], v[68:71], v[232:235]
    ds_read_b64_tr_b16 a[118:119], v244 offset:22528
    v_mfma_f32_16x16x32_bf16 v[232:235], a[128:131], v[64:67], v[232:235]
    buffer_load_dwordx4 v243, s[12:15], s30 offen offset:3072 nt lds
    v_mfma_f32_16x16x32_bf16 v[236:239], a[128:131], v[128:131], 0
    s_add_u32 m0, s32, 65536
    ds_read_b64_tr_b16 a[120:121], v244 offset:24576
    v_mfma_f32_16x16x32_bf16 v[236:239], a[132:135], v[132:135], v[236:239]
    s_sub_u32 s12, s12, 196480
    ds_read_b64_tr_b16 a[122:123], v244 offset:26624
    v_mfma_f32_16x16x32_bf16 v[236:239], a[136:139], v[136:139], v[236:239]
    s_subb_u32 s13, s13, 0
    ds_read_b64_tr_b16 a[124:125], v244 offset:28672
    v_mfma_f32_16x16x32_bf16 v[236:239], a[140:143], v[140:143], v[236:239]
    ds_read_b64_tr_b16 a[126:127], v244 offset:30720
    v_mfma_f32_16x16x32_bf16 v[236:239], a[144:147], v[144:147], v[236:239]
    s_mov_b32 s38, 135552
    v_mfma_f32_16x16x32_bf16 v[236:239], a[148:151], v[148:151], v[236:239]
    buffer_load_dwordx4 v243, s[12:15], 0 offen offset:0 nt lds
    v_mfma_f32_16x16x32_bf16 v[236:239], a[152:155], v[152:155], v[236:239]
    v_mfma_f32_16x16x32_bf16 v[236:239], a[156:159], v[156:159], v[236:239]
    s_waitcnt lgkmcnt(0)
    v_xor_b32_e32 v244, 0x20, v244
    v_mfma_f32_16x16x32_bf16 v[192:195], a[96:99], v[32:35], v[192:195]
    buffer_load_dword a243, v248, s[64:67], s38 offen
    v_mfma_f32_16x16x32_bf16 v[192:195], a[100:103], v[36:39], v[192:195]
    ds_read_b64_tr_b16 a[128:129], v244 offset:0
    v_mfma_f32_16x16x32_bf16 v[192:195], a[104:107], v[40:43], v[192:195]
    ds_read_b64_tr_b16 a[130:131], v244 offset:2048
    v_mfma_f32_16x16x32_bf16 v[192:195], a[108:111], v[44:47], v[192:195]
    ds_read_b64_tr_b16 a[132:133], v244 offset:4096
    v_mfma_f32_16x16x32_bf16 v[192:195], a[112:115], v[48:51], v[192:195]
    ds_read_b64_tr_b16 a[134:135], v244 offset:6144
    v_mfma_f32_16x16x32_bf16 v[192:195], a[116:119], v[52:55], v[192:195]
    v_mfma_f32_16x16x32_bf16 v[192:195], a[120:123], v[56:59], v[192:195]
    ds_read_b64_tr_b16 a[136:137], v244 offset:8192
    v_mfma_f32_16x16x32_bf16 v[192:195], a[124:127], v[60:63], v[192:195]
    ds_read_b64_tr_b16 a[138:139], v244 offset:10240
    v_mfma_f32_16x16x32_bf16 v[196:199], a[124:127], v[124:127], v[196:199]
    ds_read_b64_tr_b16 a[140:141], v244 offset:12288
    v_mfma_f32_16x16x32_bf16 v[196:199], a[120:123], v[120:123], v[196:199]
    ds_read_b64_tr_b16 a[142:143], v244 offset:14336
    v_mfma_f32_16x16x32_bf16 v[196:199], a[116:119], v[116:119], v[196:199]
    buffer_load_dwordx4 v243, s[12:15], s28 offen offset:1024 nt lds
    v_mfma_f32_16x16x32_bf16 v[196:199], a[112:115], v[112:115], v[196:199]
    ds_read_b64_tr_b16 a[144:145], v244 offset:16384
    v_mul_f32_e32 v192, v192, v251
    v_mfma_f32_16x16x32_bf16 v[196:199], a[108:111], v[108:111], v[196:199]
    ds_read_b64_tr_b16 a[146:147], v244 offset:18432
    v_mul_f32_e32 v193, v193, v251
    v_mfma_f32_16x16x32_bf16 v[196:199], a[104:107], v[104:107], v[196:199]
    ds_read_b64_tr_b16 a[148:149], v244 offset:20480
    v_mul_f32_e32 v194, v194, v251
    v_mfma_f32_16x16x32_bf16 v[196:199], a[100:103], v[100:103], v[196:199]
    ds_read_b64_tr_b16 a[150:151], v244 offset:22528
    v_mul_f32_e32 v195, v195, v251
    v_mfma_f32_16x16x32_bf16 v[196:199], a[96:99], v[96:99], v[196:199]
    buffer_load_dwordx4 v243, s[12:15], s29 offen offset:2048 nt lds
    v_mfma_f32_16x16x32_bf16 v[200:203], a[96:99], v[160:163], v[200:203]
    ds_read_b64_tr_b16 a[152:153], v244 offset:24576
    v_cvt_pk_bf16_f32 v192, v192, v193
    v_mfma_f32_16x16x32_bf16 v[200:203], a[100:103], v[164:167], v[200:203]
    ds_read_b64_tr_b16 a[154:155], v244 offset:26624
    v_cvt_pk_bf16_f32 v193, v194, v195
    v_mfma_f32_16x16x32_bf16 v[200:203], a[104:107], v[168:171], v[200:203]
    ds_read_b64_tr_b16 a[156:157], v244 offset:28672
    v_mul_f32_e32 v196, v196, v252
    v_mfma_f32_16x16x32_bf16 v[200:203], a[108:111], v[172:175], v[200:203]
    ds_read_b64_tr_b16 a[158:159], v244 offset:30720
    v_mul_f32_e32 v197, v197, v252
    v_mfma_f32_16x16x32_bf16 v[200:203], a[112:115], v[176:179], v[200:203]
    v_mul_f32_e32 v198, v198, v252
    v_mul_f32_e32 v199, v199, v252
    v_mfma_f32_16x16x32_bf16 v[200:203], a[116:119], v[180:183], v[200:203]
    v_cvt_pk_bf16_f32 v196, v196, v197
    v_cvt_pk_bf16_f32 v197, v198, v199
    v_mfma_f32_16x16x32_bf16 v[200:203], a[120:123], v[184:187], v[200:203]
    v_mfma_f32_16x16x32_bf16 v[200:203], a[124:127], v[188:191], v[200:203]
    s_waitcnt lgkmcnt(0)
    v_xor_b32_e32 v244, 0x60, v244
    v_mfma_f32_16x16x32_bf16 v[204:207], a[128:131], v[32:35], v[204:207]
    buffer_load_dwordx4 v243, s[12:15], s30 offen offset:3072 nt lds
    v_mfma_f32_16x16x32_bf16 v[204:207], a[132:135], v[36:39], v[204:207]
    ds_read_b64_tr_b16 a[96:97], v244 offset:0
    v_mfma_f32_16x16x32_bf16 v[204:207], a[136:139], v[40:43], v[204:207]
    ds_read_b64_tr_b16 a[98:99], v244 offset:2048
    v_mul_f32_e32 v200, v200, v253
    v_mfma_f32_16x16x32_bf16 v[204:207], a[140:143], v[44:47], v[204:207]
    s_add_u32 m0, s32, 81920
    ds_read_b64_tr_b16 a[100:101], v244 offset:4096
    v_mul_f32_e32 v201, v201, v253
    v_mfma_f32_16x16x32_bf16 v[204:207], a[144:147], v[48:51], v[204:207]
    s_add_u32 s12, s12, 0x10000
    ds_read_b64_tr_b16 a[102:103], v244 offset:6144
    v_mul_f32_e32 v202, v202, v253
    v_mfma_f32_16x16x32_bf16 v[204:207], a[148:151], v[52:55], v[204:207]
    s_addc_u32 s13, s13, 0
    v_mul_f32_e32 v203, v203, v253
    v_cvt_pk_bf16_f32 v200, v200, v201
    v_mfma_f32_16x16x32_bf16 v[204:207], a[152:155], v[56:59], v[204:207]
    ds_read_b64_tr_b16 a[104:105], v244 offset:8192
    v_cvt_pk_bf16_f32 v201, v202, v203
    v_mfma_f32_16x16x32_bf16 v[204:207], a[156:159], v[60:63], v[204:207]
    ds_read_b64_tr_b16 a[106:107], v244 offset:10240
    v_mfma_f32_16x16x32_bf16 v[208:211], a[156:159], v[124:127], v[208:211]
    ds_read_b64_tr_b16 a[108:109], v244 offset:12288
    v_mfma_f32_16x16x32_bf16 v[208:211], a[152:155], v[120:123], v[208:211]
    ds_read_b64_tr_b16 a[110:111], v244 offset:14336
    v_mfma_f32_16x16x32_bf16 v[208:211], a[148:151], v[116:119], v[208:211]
    buffer_load_dwordx4 v243, s[12:15], 0 offen offset:0 nt lds
    v_mfma_f32_16x16x32_bf16 v[208:211], a[144:147], v[112:115], v[208:211]
    ds_read_b64_tr_b16 a[112:113], v244 offset:16384
    v_mul_f32_e32 v204, v204, v251
    v_mfma_f32_16x16x32_bf16 v[208:211], a[140:143], v[108:111], v[208:211]
    ds_read_b64_tr_b16 a[114:115], v244 offset:18432
    v_mul_f32_e32 v205, v205, v251
    v_mfma_f32_16x16x32_bf16 v[208:211], a[136:139], v[104:107], v[208:211]
    ds_read_b64_tr_b16 a[116:117], v244 offset:20480
L_walk2:
L_pad4:
    s_cbranch_vccnz L_pad5
    v_mul_f32_e32 v206, v206, v251
    v_mfma_f32_16x16x32_bf16 v[208:211], a[132:135], v[100:103], v[208:211]
    ds_read_b64_tr_b16 a[118:119], v244 offset:22528
    v_mul_f32_e32 v207, v207, v251
    v_mfma_f32_16x16x32_bf16 v[208:211], a[128:131], v[96:99], v[208:211]
    v_cvt_pk_bf16_f32 v194, v204, v205
    v_cvt_pk_bf16_f32 v195, v206, v207
    v_mfma_f32_16x16x32_bf16 v[212:215], a[128:131], v[160:163], v[212:215]
    ds_read_b64_tr_b16 a[120:121], v244 offset:24576
    v_mfma_f32_16x16x32_bf16 v[212:215], a[132:135], v[164:167], v[212:215]
    ds_read_b64_tr_b16 a[122:123], v244 offset:26624
    v_mfma_f32_16x16x32_bf16 v[212:215], a[136:139], v[168:171], v[212:215]
    ds_read_b64_tr_b16 a[124:125], v244 offset:28672
    v_mul_f32_e32 v208, v208, v252
    v_mfma_f32_16x16x32_bf16 v[212:215], a[140:143], v[172:175], v[212:215]
    ds_read_b64_tr_b16 a[126:127], v244 offset:30720
    v_mul_f32_e32 v209, v209, v252
    v_mfma_f32_16x16x32_bf16 v[212:215], a[144:147], v[176:179], v[212:215]
    buffer_load_dwordx4 v243, s[12:15], s28 offen offset:1024 nt lds
    v_mfma_f32_16x16x32_bf16 v[212:215], a[148:151], v[180:183], v[212:215]
    v_permlane16_swap_b32_e32 v192, v194
    v_mfma_f32_16x16x32_bf16 v[212:215], a[152:155], v[184:187], v[212:215]
    v_permlane16_swap_b32_e32 v193, v195
    v_mfma_f32_16x16x32_bf16 v[212:215], a[156:159], v[188:191], v[212:215]
    s_waitcnt lgkmcnt(0)
    v_xor_b32_e32 v244, 0x20, v244
    v_accvgpr_write_b32 a176, v192
    v_mfma_f32_16x16x32_bf16 v[216:219], a[96:99], v[32:35], v[216:219]
    v_accvgpr_write_b32 a177, v193
    v_accvgpr_write_b32 a178, v194
    v_mfma_f32_16x16x32_bf16 v[216:219], a[100:103], v[36:39], v[216:219]
    ds_read_b64_tr_b16 a[128:129], v244 offset:0
    v_accvgpr_write_b32 a179, v195
    v_mfma_f32_16x16x32_bf16 v[216:219], a[104:107], v[40:43], v[216:219]
    ds_read_b64_tr_b16 a[130:131], v244 offset:2048
    v_mul_f32_e32 v210, v210, v252
    v_mfma_f32_16x16x32_bf16 v[216:219], a[108:111], v[44:47], v[216:219]
    ds_read_b64_tr_b16 a[132:133], v244 offset:4096
    v_mul_f32_e32 v211, v211, v252
    v_mfma_f32_16x16x32_bf16 v[216:219], a[112:115], v[48:51], v[216:219]
    ds_read_b64_tr_b16 a[134:135], v244 offset:6144
    v_cvt_pk_bf16_f32 v198, v208, v209
    v_mfma_f32_16x16x32_bf16 v[216:219], a[116:119], v[52:55], v[216:219]
    buffer_load_dwordx4 v243, s[12:15], s29 offen offset:2048 nt lds
    v_mfma_f32_16x16x32_bf16 v[216:219], a[120:123], v[56:59], v[216:219]
    ds_read_b64_tr_b16 a[136:137], v244 offset:8192
    v_cvt_pk_bf16_f32 v199, v210, v211
    v_mfma_f32_16x16x32_bf16 v[216:219], a[124:127], v[60:63], v[216:219]
    ds_read_b64_tr_b16 a[138:139], v244 offset:10240
    v_mul_f32_e32 v212, v212, v253
    v_mfma_f32_16x16x32_bf16 v[220:223], a[124:127], v[124:127], v[220:223]
    ds_read_b64_tr_b16 a[140:141], v244 offset:12288
    v_mul_f32_e32 v213, v213, v253
    v_mfma_f32_16x16x32_bf16 v[220:223], a[120:123], v[120:123], v[220:223]
    ds_read_b64_tr_b16 a[142:143], v244 offset:14336
    v_mul_f32_e32 v214, v214, v253
    v_mfma_f32_16x16x32_bf16 v[220:223], a[116:119], v[116:119], v[220:223]
    v_permlane16_swap_b32_e32 v196, v198
    v_mfma_f32_16x16x32_bf16 v[220:223], a[112:115], v[112:115], v[220:223]
    ds_read_b64_tr_b16 a[144:145], v244 offset:16384
    v_mul_f32_e32 v215, v215, v253
    v_mfma_f32_16x16x32_bf16 v[220:223], a[108:111], v[108:111], v[220:223]
    ds_read_b64_tr_b16 a[146:147], v244 offset:18432
    v_cvt_pk_bf16_f32 v202, v212, v213
    v_mfma_f32_16x16x32_bf16 v[220:223], a[104:107], v[104:107], v[220:223]
    ds_read_b64_tr_b16 a[148:149], v244 offset:20480
    v_cvt_pk_bf16_f32 v203, v214, v215
    v_mfma_f32_16x16x32_bf16 v[220:223], a[100:103], v[100:103], v[220:223]
    ds_read_b64_tr_b16 a[150:151], v244 offset:22528
    v_mul_f32_e32 v216, v216, v251
    v_mfma_f32_16x16x32_bf16 v[220:223], a[96:99], v[96:99], v[220:223]
    buffer_load_dwordx4 v243, s[12:15], s30 offen offset:3072 nt lds
    v_mfma_f32_16x16x32_bf16 v[224:227], a[96:99], v[160:163], v[224:227]
    s_add_u32 m0, s32, 98304
    ds_read_b64_tr_b16 a[152:153], v244 offset:24576
    v_mul_f32_e32 v217, v217, v251
    v_mfma_f32_16x16x32_bf16 v[224:227], a[100:103], v[164:167], v[224:227]
    s_add_u32 s12, s12, 0x10000
    ds_read_b64_tr_b16 a[154:155], v244 offset:26624
    v_mul_f32_e32 v218, v218, v251
    v_mfma_f32_16x16x32_bf16 v[224:227], a[104:107], v[168:171], v[224:227]
    s_addc_u32 s13, s13, 0
    ds_read_b64_tr_b16 a[156:157], v244 offset:28672
    v_mul_f32_e32 v219, v219, v251
    v_mfma_f32_16x16x32_bf16 v[224:227], a[108:111], v[172:175], v[224:227]
    ds_read_b64_tr_b16 a[158:159], v244 offset:30720
    v_cvt_pk_bf16_f32 v216, v216, v217
    v_mfma_f32_16x16x32_bf16 v[224:227], a[112:115], v[176:179], v[224:227]
    s_mov_b32 s38, 196992
    v_permlane16_swap_b32_e32 v197, v199
    v_mfma_f32_16x16x32_bf16 v[224:227], a[116:119], v[180:183], v[224:227]
    v_permlane16_swap_b32_e32 v200, v202
    v_mfma_f32_16x16x32_bf16 v[224:227], a[120:123], v[184:187], v[224:227]
    buffer_load_dwordx4 v243, s[12:15], 0 offen offset:0 nt lds
    v_mfma_f32_16x16x32_bf16 v[224:227], a[124:127], v[188:191], v[224:227]
    s_waitcnt vmcnt(19) lgkmcnt(0)
    v_xor_b32_e32 v244, 0x20060, v244
    v_accvgpr_write_b32 a180, v196
    v_mfma_f32_16x16x32_bf16 v[228:231], a[128:131], v[32:35], v[228:231]
    s_barrier
    v_accvgpr_write_b32 a181, v197
    v_mfma_f32_16x16x32_bf16 v[228:231], a[132:135], v[36:39], v[228:231]
    ds_read_b64_tr_b16 a[96:97], v244 offset:0
    v_accvgpr_write_b32 a182, v198
    v_mfma_f32_16x16x32_bf16 v[228:231], a[136:139], v[40:43], v[228:231]
    ds_read_b64_tr_b16 a[98:99], v244 offset:2048
    v_accvgpr_write_b32 a183, v199
    v_mfma_f32_16x16x32_bf16 v[228:231], a[140:143], v[44:47], v[228:231]
    ds_read_b64_tr_b16 a[100:101], v244 offset:4096
    v_cvt_pk_bf16_f32 v217, v218, v219
    v_mfma_f32_16x16x32_bf16 v[228:231], a[144:147], v[48:51], v[228:231]
    ds_read_b64_tr_b16 a[102:103], v244 offset:6144
    v_mul_f32_e32 v220, v220, v252
    v_mfma_f32_16x16x32_bf16 v[228:231], a[148:151], v[52:55], v[228:231]
    buffer_load_dword a244, v248, s[64:67], s38 offen
    v_mfma_f32_16x16x32_bf16 v[228:231], a[152:155], v[56:59], v[228:231]
    ds_read_b64_tr_b16 a[104:105], v244 offset:8192
    v_mul_f32_e32 v221, v221, v252
    v_mfma_f32_16x16x32_bf16 v[228:231], a[156:159], v[60:63], v[228:231]
    ds_read_b64_tr_b16 a[106:107], v244 offset:10240
    v_mul_f32_e32 v222, v222, v252
    v_mfma_f32_16x16x32_bf16 v[232:235], a[156:159], v[124:127], v[232:235]
    ds_read_b64_tr_b16 a[108:109], v244 offset:12288
    v_mul_f32_e32 v223, v223, v252
    v_mfma_f32_16x16x32_bf16 v[232:235], a[152:155], v[120:123], v[232:235]
    ds_read_b64_tr_b16 a[110:111], v244 offset:14336
    v_cvt_pk_bf16_f32 v220, v220, v221
    v_mfma_f32_16x16x32_bf16 v[232:235], a[148:151], v[116:119], v[232:235]
    buffer_load_dwordx4 v243, s[12:15], s28 offen offset:1024 nt lds
    v_mfma_f32_16x16x32_bf16 v[232:235], a[144:147], v[112:115], v[232:235]
    ds_read_b64_tr_b16 a[112:113], v244 offset:16384
    v_cvt_pk_bf16_f32 v221, v222, v223
    v_mfma_f32_16x16x32_bf16 v[232:235], a[140:143], v[108:111], v[232:235]
    ds_read_b64_tr_b16 a[114:115], v244 offset:18432
    v_mul_f32_e32 v224, v224, v253
    v_mfma_f32_16x16x32_bf16 v[232:235], a[136:139], v[104:107], v[232:235]
    ds_read_b64_tr_b16 a[116:117], v244 offset:20480
    v_mul_f32_e32 v225, v225, v253
    v_mfma_f32_16x16x32_bf16 v[232:235], a[132:135], v[100:103], v[232:235]
    ds_read_b64_tr_b16 a[118:119], v244 offset:22528
    v_mul_f32_e32 v226, v226, v253
    v_mfma_f32_16x16x32_bf16 v[232:235], a[128:131], v[96:99], v[232:235]
    v_permlane16_swap_b32_e32 v201, v203
    v_mfma_f32_16x16x32_bf16 v[236:239], a[128:131], v[160:163], v[236:239]
    ds_read_b64_tr_b16 a[120:121], v244 offset:24576
    v_accvgpr_write_b32 a184, v200
    v_mfma_f32_16x16x32_bf16 v[236:239], a[132:135], v[164:167], v[236:239]
    ds_read_b64_tr_b16 a[122:123], v244 offset:26624
    v_accvgpr_write_b32 a185, v201
    v_mfma_f32_16x16x32_bf16 v[236:239], a[136:139], v[168:171], v[236:239]
    ds_read_b64_tr_b16 a[124:125], v244 offset:28672
    v_accvgpr_write_b32 a186, v202
    v_mfma_f32_16x16x32_bf16 v[236:239], a[140:143], v[172:175], v[236:239]
    ds_read_b64_tr_b16 a[126:127], v244 offset:30720
    v_accvgpr_write_b32 a187, v203
    v_mfma_f32_16x16x32_bf16 v[236:239], a[144:147], v[176:179], v[236:239]
    buffer_load_dwordx4 v243, s[12:15], s29 offen offset:2048 nt lds
    v_mfma_f32_16x16x32_bf16 v[236:239], a[148:151], v[180:183], v[236:239]
    v_mul_f32_e32 v227, v227, v253
    v_cvt_pk_bf16_f32 v224, v224, v225
    v_mfma_f32_16x16x32_bf16 v[236:239], a[152:155], v[184:187], v[236:239]
    v_cvt_pk_bf16_f32 v225, v226, v227
    v_mul_f32_e32 v228, v228, v251
    v_mfma_f32_16x16x32_bf16 v[236:239], a[156:159], v[188:191], v[236:239]
    s_waitcnt lgkmcnt(0)
    v_xor_b32_e32 v244, 0x20, v244
    v_mul_f32_e32 v229, v229, v251
    v_mfma_f32_16x16x32_bf16 v[192:195], a[96:99], v[0:3], 0
    v_mul_f32_e32 v230, v230, v251
    v_mul_f32_e32 v231, v231, v251
    v_mfma_f32_16x16x32_bf16 v[192:195], a[100:103], v[4:7], v[192:195]
    ds_read_b64_tr_b16 a[128:129], v244 offset:0
    v_cvt_pk_bf16_f32 v218, v228, v229
    v_mfma_f32_16x16x32_bf16 v[192:195], a[104:107], v[8:11], v[192:195]
    ds_read_b64_tr_b16 a[130:131], v244 offset:2048
    v_cvt_pk_bf16_f32 v219, v230, v231
    v_mfma_f32_16x16x32_bf16 v[192:195], a[108:111], v[12:15], v[192:195]
    ds_read_b64_tr_b16 a[132:133], v244 offset:4096
    v_mul_f32_e32 v232, v232, v252
    v_mfma_f32_16x16x32_bf16 v[192:195], a[112:115], v[16:19], v[192:195]
    ds_read_b64_tr_b16 a[134:135], v244 offset:6144
    v_mul_f32_e32 v233, v233, v252
    v_mfma_f32_16x16x32_bf16 v[192:195], a[116:119], v[20:23], v[192:195]
    buffer_load_dwordx4 v243, s[12:15], s30 offen offset:3072 nt lds
    v_mfma_f32_16x16x32_bf16 v[192:195], a[120:123], v[24:27], v[192:195]
    s_add_u32 m0, s32, 114688
    ds_read_b64_tr_b16 a[136:137], v244 offset:8192
    v_mul_f32_e32 v234, v234, v252
    v_mfma_f32_16x16x32_bf16 v[192:195], a[124:127], v[28:31], v[192:195]
    s_add_u32 s12, s12, 0x10000
    ds_read_b64_tr_b16 a[138:139], v244 offset:10240
    v_mul_f32_e32 v235, v235, v252
    v_mfma_f32_16x16x32_bf16 v[196:199], a[124:127], v[92:95], 0
    s_addc_u32 s13, s13, 0
    ds_read_b64_tr_b16 a[140:141], v244 offset:12288
    v_cvt_pk_bf16_f32 v222, v232, v233
    v_mfma_f32_16x16x32_bf16 v[196:199], a[120:123], v[88:91], v[196:199]
    ds_read_b64_tr_b16 a[142:143], v244 offset:14336
    v_cvt_pk_bf16_f32 v223, v234, v235
    v_mfma_f32_16x16x32_bf16 v[196:199], a[116:119], v[84:87], v[196:199]
    buffer_load_dwordx4 v243, s[12:15], 0 offen offset:0 nt lds
    v_mfma_f32_16x16x32_bf16 v[196:199], a[112:115], v[80:83], v[196:199]
    ds_read_b64_tr_b16 a[144:145], v244 offset:16384
    v_mul_f32_e32 v236, v236, v253
    v_mfma_f32_16x16x32_bf16 v[196:199], a[108:111], v[76:79], v[196:199]
    ds_read_b64_tr_b16 a[146:147], v244 offset:18432
    v_mul_f32_e32 v237, v237, v253
    v_mfma_f32_16x16x32_bf16 v[196:199], a[104:107], v[72:75], v[196:199]
    ds_read_b64_tr_b16 a[148:149], v244 offset:20480
    v_mul_f32_e32 v238, v238, v253
    v_mfma_f32_16x16x32_bf16 v[196:199], a[100:103], v[68:71], v[196:199]
    ds_read_b64_tr_b16 a[150:151], v244 offset:22528
    v_mul_f32_e32 v239, v239, v253
    v_mfma_f32_16x16x32_bf16 v[196:199], a[96:99], v[64:67], v[196:199]
    v_permlane16_swap_b32_e32 v216, v218
    v_mfma_f32_16x16x32_bf16 v[200:203], a[96:99], v[128:131], 0
    ds_read_b64_tr_b16 a[152:153], v244 offset:24576
    v_cvt_pk_bf16_f32 v226, v236, v237
    v_mfma_f32_16x16x32_bf16 v[200:203], a[100:103], v[132:135], v[200:203]
    ds_read_b64_tr_b16 a[154:155], v244 offset:26624
    v_cvt_pk_bf16_f32 v227, v238, v239
    v_mfma_f32_16x16x32_bf16 v[200:203], a[104:107], v[136:139], v[200:203]
    ds_read_b64_tr_b16 a[156:157], v244 offset:28672
    v_mfma_f32_16x16x32_bf16 v[200:203], a[108:111], v[140:143], v[200:203]
    ds_read_b64_tr_b16 a[158:159], v244 offset:30720
    v_mfma_f32_16x16x32_bf16 v[200:203], a[112:115], v[144:147], v[200:203]
    buffer_load_dwordx4 v243, s[12:15], s28 offen offset:1024 nt lds
    v_mfma_f32_16x16x32_bf16 v[200:203], a[116:119], v[148:151], v[200:203]
    v_permlane16_swap_b32_e32 v217, v219
    v_mfma_f32_16x16x32_bf16 v[200:203], a[120:123], v[152:155], v[200:203]
    v_permlane16_swap_b32_e32 v220, v222
    v_mfma_f32_16x16x32_bf16 v[200:203], a[124:127], v[156:159], v[200:203]
    s_waitcnt lgkmcnt(0)
    v_xor_b32_e32 v244, 0x60, v244
    v_accvgpr_write_b32 a188, v216
    v_mfma_f32_16x16x32_bf16 v[204:207], a[128:131], v[0:3], 0
    v_permlane16_swap_b32_e32 v221, v223
    v_mfma_f32_16x16x32_bf16 v[204:207], a[132:135], v[4:7], v[204:207]
    ds_read_b64_tr_b16 a[96:97], v244 offset:0
    v_accvgpr_write_b32 a189, v217
    v_mfma_f32_16x16x32_bf16 v[204:207], a[136:139], v[8:11], v[204:207]
    ds_read_b64_tr_b16 a[98:99], v244 offset:2048
    v_accvgpr_write_b32 a190, v218
    v_mfma_f32_16x16x32_bf16 v[204:207], a[140:143], v[12:15], v[204:207]
    ds_read_b64_tr_b16 a[100:101], v244 offset:4096
    v_accvgpr_write_b32 a191, v219
    v_mfma_f32_16x16x32_bf16 v[204:207], a[144:147], v[16:19], v[204:207]
    ds_read_b64_tr_b16 a[102:103], v244 offset:6144
    v_accvgpr_write_b32 a192, v220
    v_mfma_f32_16x16x32_bf16 v[204:207], a[148:151], v[20:23], v[204:207]
    buffer_load_dwordx4 v243, s[12:15], s29 offen offset:2048 nt lds
    v_mfma_f32_16x16x32_bf16 v[204:207], a[152:155], v[24:27], v[204:207]
    ds_read_b64_tr_b16 a[104:105], v244 offset:8192
    v_accvgpr_write_b32 a193, v221
    v_mfma_f32_16x16x32_bf16 v[204:207], a[156:159], v[28:31], v[204:207]
    ds_read_b64_tr_b16 a[106:107], v244 offset:10240
    v_accvgpr_write_b32 a194, v222
    v_mfma_f32_16x16x32_bf16 v[208:211], a[156:159], v[92:95], 0
    ds_read_b64_tr_b16 a[108:109], v244 offset:12288
    v_accvgpr_write_b32 a195, v223
    v_mfma_f32_16x16x32_bf16 v[208:211], a[152:155], v[88:91], v[208:211]
    ds_read_b64_tr_b16 a[110:111], v244 offset:14336
    v_mfma_f32_16x16x32_bf16 v[208:211], a[148:151], v[84:87], v[208:211]
    v_permlane16_swap_b32_e32 v224, v226
    v_mfma_f32_16x16x32_bf16 v[208:211], a[144:147], v[80:83], v[208:211]
    ds_read_b64_tr_b16 a[112:113], v244 offset:16384
    v_mfma_f32_16x16x32_bf16 v[208:211], a[140:143], v[76:79], v[208:211]
    ds_read_b64_tr_b16 a[114:115], v244 offset:18432
    v_mfma_f32_16x16x32_bf16 v[208:211], a[136:139], v[72:75], v[208:211]
    ds_read_b64_tr_b16 a[116:117], v244 offset:20480
    v_mfma_f32_16x16x32_bf16 v[208:211], a[132:135], v[68:71], v[208:211]
    ds_read_b64_tr_b16 a[118:119], v244 offset:22528
    v_mfma_f32_16x16x32_bf16 v[208:211], a[128:131], v[64:67], v[208:211]
    buffer_load_dwordx4 v243, s[12:15], s30 offen offset:3072 nt lds
    v_mfma_f32_16x16x32_bf16 v[212:215], a[128:131], v[128:131], 0
    ds_read_b64_tr_b16 a[120:121], v244 offset:24576
    v_mfma_f32_16x16x32_bf16 v[212:215], a[132:135], v[132:135], v[212:215]
    s_add_u32 m0, s32, 131072
    ds_read_b64_tr_b16 a[122:123], v244 offset:26624
    v_mfma_f32_16x16x32_bf16 v[212:215], a[136:139], v[136:139], v[212:215]
    s_sub_u32 s12, s12, 196480
    ds_read_b64_tr_b16 a[124:125], v244 offset:28672
    v_mfma_f32_16x16x32_bf16 v[212:215], a[140:143], v[140:143], v[212:215]
    s_subb_u32 s13, s13, 0
    ds_read_b64_tr_b16 a[126:127], v244 offset:30720
    v_mfma_f32_16x16x32_bf16 v[212:215], a[144:147], v[144:147], v[212:215]
    s_mov_b32 s38, 201088
    v_permlane16_swap_b32_e32 v225, v227
    v_mfma_f32_16x16x32_bf16 v[212:215], a[148:151], v[148:151], v[212:215]
    v_accvgpr_write_b32 a196, v224
    v_accvgpr_write_b32 a197, v225
    v_mfma_f32_16x16x32_bf16 v[212:215], a[152:155], v[152:155], v[212:215]
    v_accvgpr_write_b32 a198, v226
    v_accvgpr_write_b32 a199, v227
    v_mfma_f32_16x16x32_bf16 v[212:215], a[156:159], v[156:159], v[212:215]
    s_waitcnt lgkmcnt(0)
    v_xor_b32_e32 v244, 0x20, v244
    v_mfma_f32_16x16x32_bf16 v[216:219], a[96:99], v[0:3], 0
    buffer_load_dwordx4 v243, s[12:15], 0 offen offset:0 nt lds
    v_mfma_f32_16x16x32_bf16 v[216:219], a[100:103], v[4:7], v[216:219]
    ds_read_b64_tr_b16 a[128:129], v244 offset:0
    v_mfma_f32_16x16x32_bf16 v[216:219], a[104:107], v[8:11], v[216:219]
    ds_read_b64_tr_b16 a[130:131], v244 offset:2048
    v_mfma_f32_16x16x32_bf16 v[216:219], a[108:111], v[12:15], v[216:219]
    ds_read_b64_tr_b16 a[132:133], v244 offset:4096
    v_mfma_f32_16x16x32_bf16 v[216:219], a[112:115], v[16:19], v[216:219]
    ds_read_b64_tr_b16 a[134:135], v244 offset:6144
    v_mfma_f32_16x16x32_bf16 v[216:219], a[116:119], v[20:23], v[216:219]
    buffer_load_dword a245, v248, s[64:67], s38 offen
    v_mfma_f32_16x16x32_bf16 v[216:219], a[120:123], v[24:27], v[216:219]
    ds_read_b64_tr_b16 a[136:137], v244 offset:8192
    v_mfma_f32_16x16x32_bf16 v[216:219], a[124:127], v[28:31], v[216:219]
    ds_read_b64_tr_b16 a[138:139], v244 offset:10240
    v_mfma_f32_16x16x32_bf16 v[220:223], a[124:127], v[92:95], 0
    ds_read_b64_tr_b16 a[140:141], v244 offset:12288
    v_mfma_f32_16x16x32_bf16 v[220:223], a[120:123], v[88:91], v[220:223]
    ds_read_b64_tr_b16 a[142:143], v244 offset:14336
    v_mfma_f32_16x16x32_bf16 v[220:223], a[116:119], v[84:87], v[220:223]
    buffer_load_dwordx4 v243, s[12:15], s28 offen offset:1024 nt lds
    v_mfma_f32_16x16x32_bf16 v[220:223], a[112:115], v[80:83], v[220:223]
    ds_read_b64_tr_b16 a[144:145], v244 offset:16384
    v_mfma_f32_16x16x32_bf16 v[220:223], a[108:111], v[76:79], v[220:223]
    ds_read_b64_tr_b16 a[146:147], v244 offset:18432
    v_mfma_f32_16x16x32_bf16 v[220:223], a[104:107], v[72:75], v[220:223]
    ds_read_b64_tr_b16 a[148:149], v244 offset:20480
    v_mfma_f32_16x16x32_bf16 v[220:223], a[100:103], v[68:71], v[220:223]
    ds_read_b64_tr_b16 a[150:151], v244 offset:22528
    v_mfma_f32_16x16x32_bf16 v[220:223], a[96:99], v[64:67], v[220:223]
    v_mfma_f32_16x16x32_bf16 v[224:227], a[96:99], v[128:131], 0
    ds_read_b64_tr_b16 a[152:153], v244 offset:24576
    v_mfma_f32_16x16x32_bf16 v[224:227], a[100:103], v[132:135], v[224:227]
    ds_read_b64_tr_b16 a[154:155], v244 offset:26624
    v_mfma_f32_16x16x32_bf16 v[224:227], a[104:107], v[136:139], v[224:227]
    ds_read_b64_tr_b16 a[156:157], v244 offset:28672
    v_mfma_f32_16x16x32_bf16 v[224:227], a[108:111], v[140:143], v[224:227]
    ds_read_b64_tr_b16 a[158:159], v244 offset:30720
    v_mfma_f32_16x16x32_bf16 v[224:227], a[112:115], v[144:147], v[224:227]
    buffer_load_dwordx4 v243, s[12:15], s29 offen offset:2048 nt lds
    v_mfma_f32_16x16x32_bf16 v[224:227], a[116:119], v[148:151], v[224:227]
    v_mfma_f32_16x16x32_bf16 v[224:227], a[120:123], v[152:155], v[224:227]
    v_mfma_f32_16x16x32_bf16 v[224:227], a[124:127], v[156:159], v[224:227]
    s_waitcnt vmcnt(22) lgkmcnt(0)
    v_xor_b32_e32 v244, 0x8060, v244
    v_mfma_f32_16x16x32_bf16 v[228:231], a[128:131], v[0:3], 0
    s_barrier
    v_mfma_f32_16x16x32_bf16 v[228:231], a[132:135], v[4:7], v[228:231]
    ds_read_b64_tr_b16 a[96:97], v244 offset:0
    v_mfma_f32_16x16x32_bf16 v[228:231], a[136:139], v[8:11], v[228:231]
    ds_read_b64_tr_b16 a[98:99], v244 offset:2048
    v_mfma_f32_16x16x32_bf16 v[228:231], a[140:143], v[12:15], v[228:231]
    ds_read_b64_tr_b16 a[100:101], v244 offset:4096
    v_mfma_f32_16x16x32_bf16 v[228:231], a[144:147], v[16:19], v[228:231]
    ds_read_b64_tr_b16 a[102:103], v244 offset:6144
    v_mfma_f32_16x16x32_bf16 v[228:231], a[148:151], v[20:23], v[228:231]
    buffer_load_dwordx4 v243, s[12:15], s30 offen offset:3072 nt lds
    v_mfma_f32_16x16x32_bf16 v[228:231], a[152:155], v[24:27], v[228:231]
    s_add_u32 m0, s32, 147456
    ds_read_b64_tr_b16 a[104:105], v244 offset:8192
    v_mfma_f32_16x16x32_bf16 v[228:231], a[156:159], v[28:31], v[228:231]
    s_add_u32 s12, s12, 0x10000
    ds_read_b64_tr_b16 a[106:107], v244 offset:10240
    v_mfma_f32_16x16x32_bf16 v[232:235], a[156:159], v[92:95], 0
    s_addc_u32 s13, s13, 0
    ds_read_b64_tr_b16 a[108:109], v244 offset:12288
    v_mfma_f32_16x16x32_bf16 v[232:235], a[152:155], v[88:91], v[232:235]
    ds_read_b64_tr_b16 a[110:111], v244 offset:14336
    v_mfma_f32_16x16x32_bf16 v[232:235], a[148:151], v[84:87], v[232:235]
    v_mfma_f32_16x16x32_bf16 v[232:235], a[144:147], v[80:83], v[232:235]
    ds_read_b64_tr_b16 a[112:113], v244 offset:16384
    v_mfma_f32_16x16x32_bf16 v[232:235], a[140:143], v[76:79], v[232:235]
    ds_read_b64_tr_b16 a[114:115], v244 offset:18432
    v_mfma_f32_16x16x32_bf16 v[232:235], a[136:139], v[72:75], v[232:235]
    ds_read_b64_tr_b16 a[116:117], v244 offset:20480
    v_mfma_f32_16x16x32_bf16 v[232:235], a[132:135], v[68:71], v[232:235]
    ds_read_b64_tr_b16 a[118:119], v244 offset:22528
    v_mfma_f32_16x16x32_bf16 v[232:235], a[128:131], v[64:67], v[232:235]
    buffer_load_dwordx4 v243, s[12:15], 0 offen offset:0 lds
    v_mfma_f32_16x16x32_bf16 v[236:239], a[128:131], v[128:131], 0
    ds_read_b64_tr_b16 a[120:121], v244 offset:24576
    v_mfma_f32_16x16x32_bf16 v[236:239], a[132:135], v[132:135], v[236:239]
    ds_read_b64_tr_b16 a[122:123], v244 offset:26624
    v_mfma_f32_16x16x32_bf16 v[236:239], a[136:139], v[136:139], v[236:239]
    ds_read_b64_tr_b16 a[124:125], v244 offset:28672
    v_mfma_f32_16x16x32_bf16 v[236:239], a[140:143], v[140:143], v[236:239]
    ds_read_b64_tr_b16 a[126:127], v244 offset:30720
    v_mfma_f32_16x16x32_bf16 v[236:239], a[144:147], v[144:147], v[236:239]
    v_mfma_f32_16x16x32_bf16 v[236:239], a[148:151], v[148:151], v[236:239]
    v_mfma_f32_16x16x32_bf16 v[236:239], a[152:155], v[152:155], v[236:239]
    buffer_load_dwordx4 v243, s[12:15], s28 offen offset:1024 lds
    v_mfma_f32_16x16x32_bf16 v[236:239], a[156:159], v[156:159], v[236:239]
    s_waitcnt lgkmcnt(0)
    v_xor_b32_e32 v244, 0x20, v244
    v_mfma_f32_16x16x32_bf16 v[192:195], a[96:99], v[32:35], v[192:195]
    v_mfma_f32_16x16x32_bf16 v[192:195], a[100:103], v[36:39], v[192:195]
    ds_read_b64_tr_b16 a[128:129], v244 offset:0
    v_mfma_f32_16x16x32_bf16 v[192:195], a[104:107], v[40:43], v[192:195]
    ds_read_b64_tr_b16 a[130:131], v244 offset:2048
    v_mfma_f32_16x16x32_bf16 v[192:195], a[108:111], v[44:47], v[192:195]
    ds_read_b64_tr_b16 a[132:133], v244 offset:4096
    v_mfma_f32_16x16x32_bf16 v[192:195], a[112:115], v[48:51], v[192:195]
    ds_read_b64_tr_b16 a[134:135], v244 offset:6144
    v_mfma_f32_16x16x32_bf16 v[192:195], a[116:119], v[52:55], v[192:195]
    v_mfma_f32_16x16x32_bf16 v[192:195], a[120:123], v[56:59], v[192:195]
    ds_read_b64_tr_b16 a[136:137], v244 offset:8192
    v_mfma_f32_16x16x32_bf16 v[192:195], a[124:127], v[60:63], v[192:195]
    ds_read_b64_tr_b16 a[138:139], v244 offset:10240
    v_mfma_f32_16x16x32_bf16 v[196:199], a[124:127], v[124:127], v[196:199]
    ds_read_b64_tr_b16 a[140:141], v244 offset:12288
    v_mfma_f32_16x16x32_bf16 v[196:199], a[120:123], v[120:123], v[196:199]
    ds_read_b64_tr_b16 a[142:143], v244 offset:14336
    v_mfma_f32_16x16x32_bf16 v[196:199], a[116:119], v[116:119], v[196:199]
    buffer_load_dwordx4 v243, s[12:15], s29 offen offset:2048 lds
    v_mfma_f32_16x16x32_bf16 v[196:199], a[112:115], v[112:115], v[196:199]
    ds_read_b64_tr_b16 a[144:145], v244 offset:16384
    v_mul_f32_e32 v192, v192, v251
    v_mfma_f32_16x16x32_bf16 v[196:199], a[108:111], v[108:111], v[196:199]
    ds_read_b64_tr_b16 a[146:147], v244 offset:18432
    v_mul_f32_e32 v193, v193, v251
    v_mfma_f32_16x16x32_bf16 v[196:199], a[104:107], v[104:107], v[196:199]
    ds_read_b64_tr_b16 a[148:149], v244 offset:20480
    v_mul_f32_e32 v194, v194, v251
    v_mfma_f32_16x16x32_bf16 v[196:199], a[100:103], v[100:103], v[196:199]
    ds_read_b64_tr_b16 a[150:151], v244 offset:22528
    v_mul_f32_e32 v195, v195, v251
    v_mfma_f32_16x16x32_bf16 v[196:199], a[96:99], v[96:99], v[196:199]
    v_cvt_pk_bf16_f32 v192, v192, v193
    v_cvt_pk_bf16_f32 v193, v194, v195
    v_mfma_f32_16x16x32_bf16 v[200:203], a[96:99], v[160:163], v[200:203]
    ds_read_b64_tr_b16 a[152:153], v244 offset:24576
    v_mfma_f32_16x16x32_bf16 v[200:203], a[100:103], v[164:167], v[200:203]
    ds_read_b64_tr_b16 a[154:155], v244 offset:26624
    v_mfma_f32_16x16x32_bf16 v[200:203], a[104:107], v[168:171], v[200:203]
    ds_read_b64_tr_b16 a[156:157], v244 offset:28672
    v_mul_f32_e32 v196, v196, v252
    v_mfma_f32_16x16x32_bf16 v[200:203], a[108:111], v[172:175], v[200:203]
    ds_read_b64_tr_b16 a[158:159], v244 offset:30720
    v_mul_f32_e32 v197, v197, v252
    v_mfma_f32_16x16x32_bf16 v[200:203], a[112:115], v[176:179], v[200:203]
    buffer_load_dwordx4 v243, s[12:15], s30 offen offset:3072 lds
    v_mfma_f32_16x16x32_bf16 v[200:203], a[116:119], v[180:183], v[200:203]
    v_mul_f32_e32 v198, v198, v252
    v_mul_f32_e32 v199, v199, v252
    v_mfma_f32_16x16x32_bf16 v[200:203], a[120:123], v[184:187], v[200:203]
    s_mov_b32 m0, s32
    v_cvt_pk_bf16_f32 v196, v196, v197
    v_cvt_pk_bf16_f32 v197, v198, v199
    v_mfma_f32_16x16x32_bf16 v[200:203], a[124:127], v[188:191], v[200:203]
    s_waitcnt lgkmcnt(0)
    v_xor_b32_e32 v244, 0x60, v244
    v_mfma_f32_16x16x32_bf16 v[204:207], a[128:131], v[32:35], v[204:207]
    s_add_u32 s12, s12, 0x10000
    v_mfma_f32_16x16x32_bf16 v[204:207], a[132:135], v[36:39], v[204:207]
    s_addc_u32 s13, s13, 0
    ds_read_b64_tr_b16 a[96:97], v244 offset:0
    v_mfma_f32_16x16x32_bf16 v[204:207], a[136:139], v[40:43], v[204:207]
    ds_read_b64_tr_b16 a[98:99], v244 offset:2048
    v_mul_f32_e32 v200, v200, v253
    v_mfma_f32_16x16x32_bf16 v[204:207], a[140:143], v[44:47], v[204:207]
    ds_read_b64_tr_b16 a[100:101], v244 offset:4096
    v_mul_f32_e32 v201, v201, v253
    v_mfma_f32_16x16x32_bf16 v[204:207], a[144:147], v[48:51], v[204:207]
    ds_read_b64_tr_b16 a[102:103], v244 offset:6144
    v_mul_f32_e32 v202, v202, v253
    v_mfma_f32_16x16x32_bf16 v[204:207], a[148:151], v[52:55], v[204:207]
    buffer_load_dwordx4 v243, s[12:15], 0 offen offset:0 lds
    v_mfma_f32_16x16x32_bf16 v[204:207], a[152:155], v[56:59], v[204:207]
    ds_read_b64_tr_b16 a[104:105], v244 offset:8192
    v_mul_f32_e32 v203, v203, v253
    v_mfma_f32_16x16x32_bf16 v[204:207], a[156:159], v[60:63], v[204:207]
    ds_read_b64_tr_b16 a[106:107], v244 offset:10240
    v_cvt_pk_bf16_f32 v200, v200, v201
    v_mfma_f32_16x16x32_bf16 v[208:211], a[156:159], v[124:127], v[208:211]
    ds_read_b64_tr_b16 a[108:109], v244 offset:12288
    v_cvt_pk_bf16_f32 v201, v202, v203
    v_mfma_f32_16x16x32_bf16 v[208:211], a[152:155], v[120:123], v[208:211]
    ds_read_b64_tr_b16 a[110:111], v244 offset:14336
    v_mfma_f32_16x16x32_bf16 v[208:211], a[148:151], v[116:119], v[208:211]
    v_mul_f32_e32 v204, v204, v251
    v_mul_f32_e32 v205, v205, v251
    v_mfma_f32_16x16x32_bf16 v[208:211], a[144:147], v[112:115], v[208:211]
    ds_read_b64_tr_b16 a[112:113], v244 offset:16384
    v_mul_f32_e32 v206, v206, v251
    v_mfma_f32_16x16x32_bf16 v[208:211], a[140:143], v[108:111], v[208:211]
    ds_read_b64_tr_b16 a[114:115], v244 offset:18432
    v_mul_f32_e32 v207, v207, v251
    v_mfma_f32_16x16x32_bf16 v[208:211], a[136:139], v[104:107], v[208:211]
    ds_read_b64_tr_b16 a[116:117], v244 offset:20480
    v_cvt_pk_bf16_f32 v194, v204, v205
    v_mfma_f32_16x16x32_bf16 v[208:211], a[132:135], v[100:103], v[208:211]
    ds_read_b64_tr_b16 a[118:119], v244 offset:22528
    v_cvt_pk_bf16_f32 v195, v206, v207
    v_mfma_f32_16x16x32_bf16 v[208:211], a[128:131], v[96:99], v[208:211]
    buffer_load_dwordx4 v243, s[12:15], s28 offen offset:1024 lds
    v_mfma_f32_16x16x32_bf16 v[212:215], a[128:131], v[160:163], v[212:215]
    ds_read_b64_tr_b16 a[120:121], v244 offset:24576
    v_mfma_f32_16x16x32_bf16 v[212:215], a[132:135], v[164:167], v[212:215]
    ds_read_b64_tr_b16 a[122:123], v244 offset:26624
    v_mfma_f32_16x16x32_bf16 v[212:215], a[136:139], v[168:171], v[212:215]
    ds_read_b64_tr_b16 a[124:125], v244 offset:28672
    v_mfma_f32_16x16x32_bf16 v[212:215], a[140:143], v[172:175], v[212:215]
    ds_read_b64_tr_b16 a[126:127], v244 offset:30720
    v_mul_f32_e32 v208, v208, v252
    v_mfma_f32_16x16x32_bf16 v[212:215], a[144:147], v[176:179], v[212:215]
    v_permlane16_swap_b32_e32 v192, v194
    v_mfma_f32_16x16x32_bf16 v[212:215], a[148:151], v[180:183], v[212:215]
    v_permlane16_swap_b32_e32 v193, v195
    v_mfma_f32_16x16x32_bf16 v[212:215], a[152:155], v[184:187], v[212:215]
    v_accvgpr_write_b32 a200, v192
    v_accvgpr_write_b32 a201, v193
    v_mfma_f32_16x16x32_bf16 v[212:215], a[156:159], v[188:191], v[212:215]
    s_waitcnt lgkmcnt(0)
    v_xor_b32_e32 v244, 0x20, v244
    v_accvgpr_write_b32 a202, v194
    v_mfma_f32_16x16x32_bf16 v[216:219], a[96:99], v[32:35], v[216:219]
    buffer_load_dwordx4 v243, s[12:15], s29 offen offset:2048 lds
    v_mfma_f32_16x16x32_bf16 v[216:219], a[100:103], v[36:39], v[216:219]
    ds_read_b64_tr_b16 a[128:129], v244 offset:0
    v_accvgpr_write_b32 a203, v195
    v_mfma_f32_16x16x32_bf16 v[216:219], a[104:107], v[40:43], v[216:219]
    ds_read_b64_tr_b16 a[130:131], v244 offset:2048
    v_mul_f32_e32 v209, v209, v252
    v_mfma_f32_16x16x32_bf16 v[216:219], a[108:111], v[44:47], v[216:219]
    ds_read_b64_tr_b16 a[132:133], v244 offset:4096
    v_mul_f32_e32 v210, v210, v252
    v_mfma_f32_16x16x32_bf16 v[216:219], a[112:115], v[48:51], v[216:219]
    ds_read_b64_tr_b16 a[134:135], v244 offset:6144
    v_mul_f32_e32 v211, v211, v252
    v_mfma_f32_16x16x32_bf16 v[216:219], a[116:119], v[52:55], v[216:219]
    v_cvt_pk_bf16_f32 v198, v208, v209
    v_cvt_pk_bf16_f32 v199, v210, v211
    v_mfma_f32_16x16x32_bf16 v[216:219], a[120:123], v[56:59], v[216:219]
    ds_read_b64_tr_b16 a[136:137], v244 offset:8192
    v_mul_f32_e32 v212, v212, v253
    v_mfma_f32_16x16x32_bf16 v[216:219], a[124:127], v[60:63], v[216:219]
    ds_read_b64_tr_b16 a[138:139], v244 offset:10240
    v_mul_f32_e32 v213, v213, v253
    v_mfma_f32_16x16x32_bf16 v[220:223], a[124:127], v[124:127], v[220:223]
    ds_read_b64_tr_b16 a[140:141], v244 offset:12288
    v_mul_f32_e32 v214, v214, v253
    v_mfma_f32_16x16x32_bf16 v[220:223], a[120:123], v[120:123], v[220:223]
    ds_read_b64_tr_b16 a[142:143], v244 offset:14336
    v_mul_f32_e32 v215, v215, v253
    v_mfma_f32_16x16x32_bf16 v[220:223], a[116:119], v[116:119], v[220:223]
    buffer_load_dwordx4 v243, s[12:15], s30 offen offset:3072 lds
    v_mfma_f32_16x16x32_bf16 v[220:223], a[112:115], v[112:115], v[220:223]
    ds_read_b64_tr_b16 a[144:145], v244 offset:16384
    v_cvt_pk_bf16_f32 v202, v212, v213
    v_mfma_f32_16x16x32_bf16 v[220:223], a[108:111], v[108:111], v[220:223]
    ds_read_b64_tr_b16 a[146:147], v244 offset:18432
    v_cvt_pk_bf16_f32 v203, v214, v215
    v_mfma_f32_16x16x32_bf16 v[220:223], a[104:107], v[104:107], v[220:223]
    ds_read_b64_tr_b16 a[148:149], v244 offset:20480
    v_mul_f32_e32 v216, v216, v251
    v_mfma_f32_16x16x32_bf16 v[220:223], a[100:103], v[100:103], v[220:223]
    s_add_u32 m0, s32, 16384
    ds_read_b64_tr_b16 a[150:151], v244 offset:22528
    v_mul_f32_e32 v217, v217, v251
    v_mfma_f32_16x16x32_bf16 v[220:223], a[96:99], v[96:99], v[220:223]
    s_add_u32 s12, s12, 0x10000
    v_permlane16_swap_b32_e32 v196, v198
L_pad5:
    s_cbranch_vccnz L_back
    v_mfma_f32_16x16x32_bf16 v[224:227], a[96:99], v[160:163], v[224:227]
    s_addc_u32 s13, s13, 0
    ds_read_b64_tr_b16 a[152:153], v244 offset:24576
    v_mul_f32_e32 v218, v218, v251
    v_mfma_f32_16x16x32_bf16 v[224:227], a[100:103], v[164:167], v[224:227]
    ds_read_b64_tr_b16 a[154:155], v244 offset:26624
    v_mul_f32_e32 v219, v219, v251
    v_mfma_f32_16x16x32_bf16 v[224:227], a[104:107], v[168:171], v[224:227]
    ds_read_b64_tr_b16 a[156:157], v244 offset:28672
    v_cvt_pk_bf16_f32 v216, v216, v217
    v_mfma_f32_16x16x32_bf16 v[224:227], a[108:111], v[172:175], v[224:227]
    ds_read_b64_tr_b16 a[158:159], v244 offset:30720
    v_cvt_pk_bf16_f32 v217, v218, v219
    v_mfma_f32_16x16x32_bf16 v[224:227], a[112:115], v[176:179], v[224:227]
    buffer_load_dwordx4 v243, s[12:15], 0 offen offset:0 lds
    v_mfma_f32_16x16x32_bf16 v[224:227], a[116:119], v[180:183], v[224:227]
    v_permlane16_swap_b32_e32 v197, v199
    v_mfma_f32_16x16x32_bf16 v[224:227], a[120:123], v[184:187], v[224:227]
    v_permlane16_swap_b32_e32 v200, v202
    v_mfma_f32_16x16x32_bf16 v[224:227], a[124:127], v[188:191], v[224:227]
    s_waitcnt vmcnt(23) lgkmcnt(0)
    v_xor_b32_e32 v244, 0x18060, v244
    v_accvgpr_write_b32 a204, v196
    v_mfma_f32_16x16x32_bf16 v[228:231], a[128:131], v[32:35], v[228:231]
    s_barrier
    v_accvgpr_write_b32 a205, v197
    v_mfma_f32_16x16x32_bf16 v[228:231], a[132:135], v[36:39], v[228:231]
    ds_read_b64_tr_b16 a[96:97], v244 offset:0
    v_accvgpr_write_b32 a206, v198
    v_mfma_f32_16x16x32_bf16 v[228:231], a[136:139], v[40:43], v[228:231]
    ds_read_b64_tr_b16 a[98:99], v244 offset:2048
    v_accvgpr_write_b32 a207, v199
    v_mfma_f32_16x16x32_bf16 v[228:231], a[140:143], v[44:47], v[228:231]
    ds_read_b64_tr_b16 a[100:101], v244 offset:4096
    v_mul_f32_e32 v220, v220, v252
    v_mfma_f32_16x16x32_bf16 v[228:231], a[144:147], v[48:51], v[228:231]
    ds_read_b64_tr_b16 a[102:103], v244 offset:6144
    v_mul_f32_e32 v221, v221, v252
    v_mfma_f32_16x16x32_bf16 v[228:231], a[148:151], v[52:55], v[228:231]
    v_permlane16_swap_b32_e32 v201, v203
    v_mfma_f32_16x16x32_bf16 v[228:231], a[152:155], v[56:59], v[228:231]
    ds_read_b64_tr_b16 a[104:105], v244 offset:8192
    v_accvgpr_write_b32 a208, v200
    v_mfma_f32_16x16x32_bf16 v[228:231], a[156:159], v[60:63], v[228:231]
    ds_read_b64_tr_b16 a[106:107], v244 offset:10240
    v_accvgpr_write_b32 a209, v201
    v_mfma_f32_16x16x32_bf16 v[232:235], a[156:159], v[124:127], v[232:235]
    ds_read_b64_tr_b16 a[108:109], v244 offset:12288
    v_accvgpr_write_b32 a210, v202
    v_mfma_f32_16x16x32_bf16 v[232:235], a[152:155], v[120:123], v[232:235]
    ds_read_b64_tr_b16 a[110:111], v244 offset:14336
    v_accvgpr_write_b32 a211, v203
    v_mfma_f32_16x16x32_bf16 v[232:235], a[148:151], v[116:119], v[232:235]
    buffer_load_dwordx4 v243, s[12:15], s28 offen offset:1024 lds
    v_mfma_f32_16x16x32_bf16 v[232:235], a[144:147], v[112:115], v[232:235]
    ds_read_b64_tr_b16 a[112:113], v244 offset:16384
    v_mul_f32_e32 v222, v222, v252
    v_mfma_f32_16x16x32_bf16 v[232:235], a[140:143], v[108:111], v[232:235]
    ds_read_b64_tr_b16 a[114:115], v244 offset:18432
    v_mul_f32_e32 v223, v223, v252
    v_mfma_f32_16x16x32_bf16 v[232:235], a[136:139], v[104:107], v[232:235]
    ds_read_b64_tr_b16 a[116:117], v244 offset:20480
    v_cvt_pk_bf16_f32 v220, v220, v221
    v_mfma_f32_16x16x32_bf16 v[232:235], a[132:135], v[100:103], v[232:235]
    ds_read_b64_tr_b16 a[118:119], v244 offset:22528
    v_cvt_pk_bf16_f32 v221, v222, v223
    v_mfma_f32_16x16x32_bf16 v[232:235], a[128:131], v[96:99], v[232:235]
    v_mul_f32_e32 v224, v224, v253
    v_mul_f32_e32 v225, v225, v253
    v_mfma_f32_16x16x32_bf16 v[236:239], a[128:131], v[160:163], v[236:239]
    ds_read_b64_tr_b16 a[120:121], v244 offset:24576
    v_mul_f32_e32 v226, v226, v253
    v_mfma_f32_16x16x32_bf16 v[236:239], a[132:135], v[164:167], v[236:239]
    ds_read_b64_tr_b16 a[122:123], v244 offset:26624
    v_mul_f32_e32 v227, v227, v253
    v_mfma_f32_16x16x32_bf16 v[236:239], a[136:139], v[168:171], v[236:239]
    ds_read_b64_tr_b16 a[124:125], v244 offset:28672
    v_cvt_pk_bf16_f32 v224, v224, v225
    v_mfma_f32_16x16x32_bf16 v[236:239], a[140:143], v[172:175], v[236:239]
    ds_read_b64_tr_b16 a[126:127], v244 offset:30720
    v_cvt_pk_bf16_f32 v225, v226, v227
    v_mfma_f32_16x16x32_bf16 v[236:239], a[144:147], v[176:179], v[236:239]
    buffer_load_dwordx4 v243, s[12:15], s29 offen offset:2048 lds
    v_mfma_f32_16x16x32_bf16 v[236:239], a[148:151], v[180:183], v[236:239]
    v_mul_f32_e32 v228, v228, v251
    v_mul_f32_e32 v229, v229, v251
    v_mfma_f32_16x16x32_bf16 v[236:239], a[152:155], v[184:187], v[236:239]
    v_mul_f32_e32 v230, v230, v251
    v_mul_f32_e32 v231, v231, v251
    v_mfma_f32_16x16x32_bf16 v[236:239], a[156:159], v[188:191], v[236:239]
    s_waitcnt lgkmcnt(0)
    v_xor_b32_e32 v244, 0x20, v244
    v_cvt_pk_bf16_f32 v218, v228, v229
    v_mfma_f32_16x16x32_bf16 v[192:195], a[96:99], v[0:3], 0
    v_cvt_pk_bf16_f32 v219, v230, v231
    v_mul_f32_e32 v232, v232, v252
    v_mfma_f32_16x16x32_bf16 v[192:195], a[100:103], v[4:7], v[192:195]
    ds_read_b64_tr_b16 a[128:129], v244 offset:0
    v_mul_f32_e32 v233, v233, v252
    v_mfma_f32_16x16x32_bf16 v[192:195], a[104:107], v[8:11], v[192:195]
    ds_read_b64_tr_b16 a[130:131], v244 offset:2048
    v_mul_f32_e32 v234, v234, v252
    v_mfma_f32_16x16x32_bf16 v[192:195], a[108:111], v[12:15], v[192:195]
    ds_read_b64_tr_b16 a[132:133], v244 offset:4096
    v_mul_f32_e32 v235, v235, v252
    v_mfma_f32_16x16x32_bf16 v[192:195], a[112:115], v[16:19], v[192:195]
    ds_read_b64_tr_b16 a[134:135], v244 offset:6144
    v_cvt_pk_bf16_f32 v222, v232, v233
    v_mfma_f32_16x16x32_bf16 v[192:195], a[116:119], v[20:23], v[192:195]
    buffer_load_dwordx4 v243, s[12:15], s30 offen offset:3072 lds
    v_mfma_f32_16x16x32_bf16 v[192:195], a[120:123], v[24:27], v[192:195]
    ds_read_b64_tr_b16 a[136:137], v244 offset:8192
    v_cvt_pk_bf16_f32 v223, v234, v235
    v_mfma_f32_16x16x32_bf16 v[192:195], a[124:127], v[28:31], v[192:195]
    ds_read_b64_tr_b16 a[138:139], v244 offset:10240
    v_mul_f32_e32 v236, v236, v253
    v_mfma_f32_16x16x32_bf16 v[196:199], a[124:127], v[92:95], 0
    ds_read_b64_tr_b16 a[140:141], v244 offset:12288
    v_mul_f32_e32 v237, v237, v253
    v_mfma_f32_16x16x32_bf16 v[196:199], a[120:123], v[88:91], v[196:199]
    ds_read_b64_tr_b16 a[142:143], v244 offset:14336
    v_mul_f32_e32 v238, v238, v253
    v_mfma_f32_16x16x32_bf16 v[196:199], a[116:119], v[84:87], v[196:199]
    v_permlane16_swap_b32_e32 v216, v218
    v_mfma_f32_16x16x32_bf16 v[196:199], a[112:115], v[80:83], v[196:199]
    ds_read_b64_tr_b16 a[144:145], v244 offset:16384
    v_mul_f32_e32 v239, v239, v253
    v_mfma_f32_16x16x32_bf16 v[196:199], a[108:111], v[76:79], v[196:199]
    ds_read_b64_tr_b16 a[146:147], v244 offset:18432
    v_cvt_pk_bf16_f32 v226, v236, v237
    v_mfma_f32_16x16x32_bf16 v[196:199], a[104:107], v[72:75], v[196:199]
    ds_read_b64_tr_b16 a[148:149], v244 offset:20480
    v_cvt_pk_bf16_f32 v227, v238, v239
    v_mfma_f32_16x16x32_bf16 v[196:199], a[100:103], v[68:71], v[196:199]
    ds_read_b64_tr_b16 a[150:151], v244 offset:22528
    v_mfma_f32_16x16x32_bf16 v[196:199], a[96:99], v[64:67], v[196:199]
    ds_write_b32 v255, v254
    v_mfma_f32_16x16x32_bf16 v[200:203], a[96:99], v[128:131], 0
    ds_read_b64_tr_b16 a[152:153], v244 offset:24576
    v_mfma_f32_16x16x32_bf16 v[200:203], a[100:103], v[132:135], v[200:203]
    ds_read_b64_tr_b16 a[154:155], v244 offset:26624
    v_mfma_f32_16x16x32_bf16 v[200:203], a[104:107], v[136:139], v[200:203]
    ds_read_b64_tr_b16 a[156:157], v244 offset:28672
    v_mfma_f32_16x16x32_bf16 v[200:203], a[108:111], v[140:143], v[200:203]
    ds_read_b64_tr_b16 a[158:159], v244 offset:30720
    v_mfma_f32_16x16x32_bf16 v[200:203], a[112:115], v[144:147], v[200:203]
    v_permlane16_swap_b32_e32 v217, v219
    v_mfma_f32_16x16x32_bf16 v[200:203], a[116:119], v[148:151], v[200:203]
    v_permlane16_swap_b32_e32 v220, v222
    v_mfma_f32_16x16x32_bf16 v[200:203], a[120:123], v[152:155], v[200:203]
    v_permlane16_swap_b32_e32 v221, v223
    v_mfma_f32_16x16x32_bf16 v[200:203], a[124:127], v[156:159], v[200:203]
    s_waitcnt lgkmcnt(0)
    v_xor_b32_e32 v244, 0x60, v244
    v_accvgpr_write_b32 a212, v216
    v_mfma_f32_16x16x32_bf16 v[204:207], a[128:131], v[0:3], 0
    v_permlane16_swap_b32_e32 v224, v226
    v_mfma_f32_16x16x32_bf16 v[204:207], a[132:135], v[4:7], v[204:207]
    ds_read_b64_tr_b16 a[96:97], v244 offset:0
    v_accvgpr_write_b32 a213, v217
    v_mfma_f32_16x16x32_bf16 v[204:207], a[136:139], v[8:11], v[204:207]
    ds_read_b64_tr_b16 a[98:99], v244 offset:2048
    v_accvgpr_write_b32 a214, v218
    v_mfma_f32_16x16x32_bf16 v[204:207], a[140:143], v[12:15], v[204:207]
    ds_read_b64_tr_b16 a[100:101], v244 offset:4096
    v_accvgpr_write_b32 a215, v219
    v_mfma_f32_16x16x32_bf16 v[204:207], a[144:147], v[16:19], v[204:207]
    ds_read_b64_tr_b16 a[102:103], v244 offset:6144
    v_accvgpr_write_b32 a216, v220
    v_mfma_f32_16x16x32_bf16 v[204:207], a[148:151], v[20:23], v[204:207]
    v_permlane16_swap_b32_e32 v225, v227
    v_mfma_f32_16x16x32_bf16 v[204:207], a[152:155], v[24:27], v[204:207]
    ds_read_b64_tr_b16 a[104:105], v244 offset:8192
    v_accvgpr_write_b32 a217, v221
    v_mfma_f32_16x16x32_bf16 v[204:207], a[156:159], v[28:31], v[204:207]
    ds_read_b64_tr_b16 a[106:107], v244 offset:10240
    v_accvgpr_write_b32 a218, v222
    v_mfma_f32_16x16x32_bf16 v[208:211], a[156:159], v[92:95], 0
    ds_read_b64_tr_b16 a[108:109], v244 offset:12288
    v_accvgpr_write_b32 a219, v223
    v_mfma_f32_16x16x32_bf16 v[208:211], a[152:155], v[88:91], v[208:211]
    ds_read_b64_tr_b16 a[110:111], v244 offset:14336
    v_accvgpr_write_b32 a220, v224
    v_mfma_f32_16x16x32_bf16 v[208:211], a[148:151], v[84:87], v[208:211]
    v_accvgpr_write_b32 a221, v225
    v_accvgpr_write_b32 a222, v226
    v_mfma_f32_16x16x32_bf16 v[208:211], a[144:147], v[80:83], v[208:211]
    ds_read_b64_tr_b16 a[112:113], v244 offset:16384
    v_accvgpr_write_b32 a223, v227
    v_mfma_f32_16x16x32_bf16 v[208:211], a[140:143], v[76:79], v[208:211]
    ds_read_b64_tr_b16 a[114:115], v244 offset:18432
    v_mfma_f32_16x16x32_bf16 v[208:211], a[136:139], v[72:75], v[208:211]
    ds_read_b64_tr_b16 a[116:117], v244 offset:20480
    v_mfma_f32_16x16x32_bf16 v[208:211], a[132:135], v[68:71], v[208:211]
    ds_read_b64_tr_b16 a[118:119], v244 offset:22528
    v_mfma_f32_16x16x32_bf16 v[208:211], a[128:131], v[64:67], v[208:211]
    v_mfma_f32_16x16x32_bf16 v[212:215], a[128:131], v[128:131], 0
    ds_read_b64_tr_b16 a[120:121], v244 offset:24576
    v_mfma_f32_16x16x32_bf16 v[212:215], a[132:135], v[132:135], v[212:215]
    ds_read_b64_tr_b16 a[122:123], v244 offset:26624
    v_mfma_f32_16x16x32_bf16 v[212:215], a[136:139], v[136:139], v[212:215]
    ds_read_b64_tr_b16 a[124:125], v244 offset:28672
    v_mfma_f32_16x16x32_bf16 v[212:215], a[140:143], v[140:143], v[212:215]
    ds_read_b64_tr_b16 a[126:127], v244 offset:30720
    v_mfma_f32_16x16x32_bf16 v[212:215], a[144:147], v[144:147], v[212:215]
    v_mfma_f32_16x16x32_bf16 v[212:215], a[148:151], v[148:151], v[212:215]
    v_mfma_f32_16x16x32_bf16 v[212:215], a[152:155], v[152:155], v[212:215]
    v_mfma_f32_16x16x32_bf16 v[212:215], a[156:159], v[156:159], v[212:215]
    s_waitcnt lgkmcnt(0)
    v_xor_b32_e32 v244, 0x20, v244
    v_mfma_f32_16x16x32_bf16 v[216:219], a[96:99], v[0:3], 0
    v_mfma_f32_16x16x32_bf16 v[216:219], a[100:103], v[4:7], v[216:219]
    ds_read_b64_tr_b16 a[128:129], v244 offset:0
    v_mfma_f32_16x16x32_bf16 v[216:219], a[104:107], v[8:11], v[216:219]
    ds_read_b64_tr_b16 a[130:131], v244 offset:2048
    v_mfma_f32_16x16x32_bf16 v[216:219], a[108:111], v[12:15], v[216:219]
    ds_read_b64_tr_b16 a[132:133], v244 offset:4096
    v_mfma_f32_16x16x32_bf16 v[216:219], a[112:115], v[16:19], v[216:219]
    ds_read_b64_tr_b16 a[134:135], v244 offset:6144
    v_mfma_f32_16x16x32_bf16 v[216:219], a[116:119], v[20:23], v[216:219]
    v_mfma_f32_16x16x32_bf16 v[216:219], a[120:123], v[24:27], v[216:219]
    ds_read_b64_tr_b16 a[136:137], v244 offset:8192
    v_mfma_f32_16x16x32_bf16 v[216:219], a[124:127], v[28:31], v[216:219]
    ds_read_b64_tr_b16 a[138:139], v244 offset:10240
    v_mfma_f32_16x16x32_bf16 v[220:223], a[124:127], v[92:95], 0
    ds_read_b64_tr_b16 a[140:141], v244 offset:12288
    v_mfma_f32_16x16x32_bf16 v[220:223], a[120:123], v[88:91], v[220:223]
    ds_read_b64_tr_b16 a[142:143], v244 offset:14336
    v_mfma_f32_16x16x32_bf16 v[220:223], a[116:119], v[84:87], v[220:223]
    v_mfma_f32_16x16x32_bf16 v[220:223], a[112:115], v[80:83], v[220:223]
    ds_read_b64_tr_b16 a[144:145], v244 offset:16384
    v_mfma_f32_16x16x32_bf16 v[220:223], a[108:111], v[76:79], v[220:223]
    ds_read_b64_tr_b16 a[146:147], v244 offset:18432
    v_mfma_f32_16x16x32_bf16 v[220:223], a[104:107], v[72:75], v[220:223]
    ds_read_b64_tr_b16 a[148:149], v244 offset:20480
    v_mfma_f32_16x16x32_bf16 v[220:223], a[100:103], v[68:71], v[220:223]
    ds_read_b64_tr_b16 a[150:151], v244 offset:22528
    v_mfma_f32_16x16x32_bf16 v[220:223], a[96:99], v[64:67], v[220:223]
    v_mfma_f32_16x16x32_bf16 v[224:227], a[96:99], v[128:131], 0
    ds_read_b64_tr_b16 a[152:153], v244 offset:24576
    v_mfma_f32_16x16x32_bf16 v[224:227], a[100:103], v[132:135], v[224:227]
    ds_read_b64_tr_b16 a[154:155], v244 offset:26624
    v_mfma_f32_16x16x32_bf16 v[224:227], a[104:107], v[136:139], v[224:227]
    ds_read_b64_tr_b16 a[156:157], v244 offset:28672
    v_mfma_f32_16x16x32_bf16 v[224:227], a[108:111], v[140:143], v[224:227]
    ds_read_b64_tr_b16 a[158:159], v244 offset:30720
    v_mfma_f32_16x16x32_bf16 v[224:227], a[112:115], v[144:147], v[224:227]
    v_mfma_f32_16x16x32_bf16 v[224:227], a[116:119], v[148:151], v[224:227]
    v_mfma_f32_16x16x32_bf16 v[224:227], a[120:123], v[152:155], v[224:227]
    v_mfma_f32_16x16x32_bf16 v[224:227], a[124:127], v[156:159], v[224:227]
    s_waitcnt vmcnt(0) lgkmcnt(0)
    v_xor_b32_e32 v244, 0x8060, v244
    v_mfma_f32_16x16x32_bf16 v[228:231], a[128:131], v[0:3], 0
    s_barrier
    v_mfma_f32_16x16x32_bf16 v[228:231], a[132:135], v[4:7], v[228:231]
    ds_read_b64_tr_b16 a[96:97], v244 offset:0
    v_mfma_f32_16x16x32_bf16 v[228:231], a[136:139], v[8:11], v[228:231]
    ds_read_b64_tr_b16 a[98:99], v244 offset:2048
    v_mfma_f32_16x16x32_bf16 v[228:231], a[140:143], v[12:15], v[228:231]
    ds_read_b64_tr_b16 a[100:101], v244 offset:4096
    v_mfma_f32_16x16x32_bf16 v[228:231], a[144:147], v[16:19], v[228:231]
    ds_read_b64_tr_b16 a[102:103], v244 offset:6144
    v_mfma_f32_16x16x32_bf16 v[228:231], a[148:151], v[20:23], v[228:231]
    buffer_store_dwordx4 a[176:179], v247, s[16:19], 0 offen offset:0 sc0 sc1
    v_mfma_f32_16x16x32_bf16 v[228:231], a[152:155], v[24:27], v[228:231]
    ds_read_b64_tr_b16 a[104:105], v244 offset:8192
    v_mfma_f32_16x16x32_bf16 v[228:231], a[156:159], v[28:31], v[228:231]
    ds_read_b64_tr_b16 a[106:107], v244 offset:10240
    v_mfma_f32_16x16x32_bf16 v[232:235], a[156:159], v[92:95], 0
    ds_read_b64_tr_b16 a[108:109], v244 offset:12288
    v_mfma_f32_16x16x32_bf16 v[232:235], a[152:155], v[88:91], v[232:235]
    ds_read_b64_tr_b16 a[110:111], v244 offset:14336
    v_mfma_f32_16x16x32_bf16 v[232:235], a[148:151], v[84:87], v[232:235]
    v_mfma_f32_16x16x32_bf16 v[232:235], a[144:147], v[80:83], v[232:235]
    ds_read_b64_tr_b16 a[112:113], v244 offset:16384
    v_mfma_f32_16x16x32_bf16 v[232:235], a[140:143], v[76:79], v[232:235]
    ds_read_b64_tr_b16 a[114:115], v244 offset:18432
    v_mfma_f32_16x16x32_bf16 v[232:235], a[136:139], v[72:75], v[232:235]
    ds_read_b64_tr_b16 a[116:117], v244 offset:20480
    v_mfma_f32_16x16x32_bf16 v[232:235], a[132:135], v[68:71], v[232:235]
    ds_read_b64_tr_b16 a[118:119], v244 offset:22528
    v_mfma_f32_16x16x32_bf16 v[232:235], a[128:131], v[64:67], v[232:235]
    buffer_store_dwordx4 a[180:183], v247, s[16:19], s45 offen offset:0 sc0 sc1
    v_mfma_f32_16x16x32_bf16 v[236:239], a[128:131], v[128:131], 0
    ds_read_b64_tr_b16 a[120:121], v244 offset:24576
    v_mfma_f32_16x16x32_bf16 v[236:239], a[132:135], v[132:135], v[236:239]
    ds_read_b64_tr_b16 a[122:123], v244 offset:26624
    v_mfma_f32_16x16x32_bf16 v[236:239], a[136:139], v[136:139], v[236:239]
    ds_read_b64_tr_b16 a[124:125], v244 offset:28672
    v_mfma_f32_16x16x32_bf16 v[236:239], a[140:143], v[140:143], v[236:239]
    ds_read_b64_tr_b16 a[126:127], v244 offset:30720
    v_mfma_f32_16x16x32_bf16 v[236:239], a[144:147], v[144:147], v[236:239]
    v_mfma_f32_16x16x32_bf16 v[236:239], a[148:151], v[148:151], v[236:239]
    v_mfma_f32_16x16x32_bf16 v[236:239], a[152:155], v[152:155], v[236:239]
    v_mfma_f32_16x16x32_bf16 v[236:239], a[156:159], v[156:159], v[236:239]
    s_waitcnt lgkmcnt(0)
    v_xor_b32_e32 v244, 0x20, v244
    v_mfma_f32_16x16x32_bf16 v[192:195], a[96:99], v[32:35], v[192:195]
    v_mfma_f32_16x16x32_bf16 v[192:195], a[100:103], v[36:39], v[192:195]
    ds_read_b64_tr_b16 a[128:129], v244 offset:0
    v_mfma_f32_16x16x32_bf16 v[192:195], a[104:107], v[40:43], v[192:195]
    ds_read_b64_tr_b16 a[130:131], v244 offset:2048
    v_mfma_f32_16x16x32_bf16 v[192:195], a[108:111], v[44:47], v[192:195]
    ds_read_b64_tr_b16 a[132:133], v244 offset:4096
    v_mfma_f32_16x16x32_bf16 v[192:195], a[112:115], v[48:51], v[192:195]
    ds_read_b64_tr_b16 a[134:135], v244 offset:6144
    v_mfma_f32_16x16x32_bf16 v[192:195], a[116:119], v[52:55], v[192:195]
    buffer_store_dwordx4 a[184:187], v247, s[20:23], 0 offen offset:0 sc0 sc1
    v_mfma_f32_16x16x32_bf16 v[192:195], a[120:123], v[56:59], v[192:195]
    ds_read_b64_tr_b16 a[136:137], v244 offset:8192
    v_mfma_f32_16x16x32_bf16 v[192:195], a[124:127], v[60:63], v[192:195]
    ds_read_b64_tr_b16 a[138:139], v244 offset:10240
    v_mfma_f32_16x16x32_bf16 v[196:199], a[124:127], v[124:127], v[196:199]
    ds_read_b64_tr_b16 a[140:141], v244 offset:12288
    v_mfma_f32_16x16x32_bf16 v[196:199], a[120:123], v[120:123], v[196:199]
    ds_read_b64_tr_b16 a[142:143], v244 offset:14336
    v_mfma_f32_16x16x32_bf16 v[196:199], a[116:119], v[116:119], v[196:199]
    v_mfma_f32_16x16x32_bf16 v[196:199], a[112:115], v[112:115], v[196:199]
    ds_read_b64_tr_b16 a[144:145], v244 offset:16384
    v_mul_f32_e32 v192, v192, v251
    v_mfma_f32_16x16x32_bf16 v[196:199], a[108:111], v[108:111], v[196:199]
    ds_read_b64_tr_b16 a[146:147], v244 offset:18432
    v_mul_f32_e32 v193, v193, v251
    v_mfma_f32_16x16x32_bf16 v[196:199], a[104:107], v[104:107], v[196:199]
    ds_read_b64_tr_b16 a[148:149], v244 offset:20480
    v_mul_f32_e32 v194, v194, v251
    v_mfma_f32_16x16x32_bf16 v[196:199], a[100:103], v[100:103], v[196:199]
    ds_read_b64_tr_b16 a[150:151], v244 offset:22528
    v_mul_f32_e32 v195, v195, v251
    v_mfma_f32_16x16x32_bf16 v[196:199], a[96:99], v[96:99], v[196:199]
    v_cvt_pk_bf16_f32 v192, v192, v193
    v_cvt_pk_bf16_f32 v193, v194, v195
    v_mfma_f32_16x16x32_bf16 v[200:203], a[96:99], v[160:163], v[200:203]
    ds_read_b64_tr_b16 a[152:153], v244 offset:24576
    v_mfma_f32_16x16x32_bf16 v[200:203], a[100:103], v[164:167], v[200:203]
    ds_read_b64_tr_b16 a[154:155], v244 offset:26624
    v_mfma_f32_16x16x32_bf16 v[200:203], a[104:107], v[168:171], v[200:203]
    ds_read_b64_tr_b16 a[156:157], v244 offset:28672
    v_mul_f32_e32 v196, v196, v252
    v_mfma_f32_16x16x32_bf16 v[200:203], a[108:111], v[172:175], v[200:203]
    ds_read_b64_tr_b16 a[158:159], v244 offset:30720
    v_mul_f32_e32 v197, v197, v252
    v_mfma_f32_16x16x32_bf16 v[200:203], a[112:115], v[176:179], v[200:203]
    buffer_store_dwordx4 a[188:191], v247, s[16:19], 0 offen offset:64 sc0 sc1
    v_mfma_f32_16x16x32_bf16 v[200:203], a[116:119], v[180:183], v[200:203]
    v_mul_f32_e32 v198, v198, v252
    v_mul_f32_e32 v199, v199, v252
    v_mfma_f32_16x16x32_bf16 v[200:203], a[120:123], v[184:187], v[200:203]
    v_cvt_pk_bf16_f32 v196, v196, v197
    v_cvt_pk_bf16_f32 v197, v198, v199
    v_mfma_f32_16x16x32_bf16 v[200:203], a[124:127], v[188:191], v[200:203]
    s_waitcnt lgkmcnt(0)
    v_xor_b32_e32 v244, 0x60, v244
    v_mfma_f32_16x16x32_bf16 v[204:207], a[128:131], v[32:35], v[204:207]
    v_mfma_f32_16x16x32_bf16 v[204:207], a[132:135], v[36:39], v[204:207]
    ds_read_b64_tr_b16 a[96:97], v244 offset:0
    v_mfma_f32_16x16x32_bf16 v[204:207], a[136:139], v[40:43], v[204:207]
    ds_read_b64_tr_b16 a[98:99], v244 offset:2048
    v_mfma_f32_16x16x32_bf16 v[204:207], a[140:143], v[44:47], v[204:207]
    ds_read_b64_tr_b16 a[100:101], v244 offset:4096
    v_mul_f32_e32 v200, v200, v253
    v_mfma_f32_16x16x32_bf16 v[204:207], a[144:147], v[48:51], v[204:207]
    ds_read_b64_tr_b16 a[102:103], v244 offset:6144
    v_mul_f32_e32 v201, v201, v253
    v_mfma_f32_16x16x32_bf16 v[204:207], a[148:151], v[52:55], v[204:207]
    v_mul_f32_e32 v202, v202, v253
    v_mul_f32_e32 v203, v203, v253
    v_mfma_f32_16x16x32_bf16 v[204:207], a[152:155], v[56:59], v[204:207]
    ds_read_b64_tr_b16 a[104:105], v244 offset:8192
    v_cvt_pk_bf16_f32 v200, v200, v201
    v_mfma_f32_16x16x32_bf16 v[204:207], a[156:159], v[60:63], v[204:207]
    ds_read_b64_tr_b16 a[106:107], v244 offset:10240
    v_cvt_pk_bf16_f32 v201, v202, v203
    v_mfma_f32_16x16x32_bf16 v[208:211], a[156:159], v[124:127], v[208:211]
    ds_read_b64_tr_b16 a[108:109], v244 offset:12288
    v_mfma_f32_16x16x32_bf16 v[208:211], a[152:155], v[120:123], v[208:211]
    ds_read_b64_tr_b16 a[110:111], v244 offset:14336
    v_mfma_f32_16x16x32_bf16 v[208:211], a[148:151], v[116:119], v[208:211]
    buffer_store_dwordx4 a[192:195], v247, s[16:19], s45 offen offset:64 sc0 sc1
    v_mfma_f32_16x16x32_bf16 v[208:211], a[144:147], v[112:115], v[208:211]
    ds_read_b64_tr_b16 a[112:113], v244 offset:16384
    v_mul_f32_e32 v204, v204, v251
    v_mfma_f32_16x16x32_bf16 v[208:211], a[140:143], v[108:111], v[208:211]
    ds_read_b64_tr_b16 a[114:115], v244 offset:18432
    v_mul_f32_e32 v205, v205, v251
    v_mfma_f32_16x16x32_bf16 v[208:211], a[136:139], v[104:107], v[208:211]
    ds_read_b64_tr_b16 a[116:117], v244 offset:20480
    v_mul_f32_e32 v206, v206, v251
    v_mfma_f32_16x16x32_bf16 v[208:211], a[132:135], v[100:103], v[208:211]
    ds_read_b64_tr_b16 a[118:119], v244 offset:22528
    v_mul_f32_e32 v207, v207, v251
    v_mfma_f32_16x16x32_bf16 v[208:211], a[128:131], v[96:99], v[208:211]
    v_cvt_pk_bf16_f32 v194, v204, v205
    v_cvt_pk_bf16_f32 v195, v206, v207
    v_mfma_f32_16x16x32_bf16 v[212:215], a[128:131], v[160:163], v[212:215]
    ds_read_b64_tr_b16 a[120:121], v244 offset:24576
    v_mfma_f32_16x16x32_bf16 v[212:215], a[132:135], v[164:167], v[212:215]
    ds_read_b64_tr_b16 a[122:123], v244 offset:26624
    v_mfma_f32_16x16x32_bf16 v[212:215], a[136:139], v[168:171], v[212:215]
    ds_read_b64_tr_b16 a[124:125], v244 offset:28672
    v_mul_f32_e32 v208, v208, v252
    v_mfma_f32_16x16x32_bf16 v[212:215], a[140:143], v[172:175], v[212:215]
    ds_read_b64_tr_b16 a[126:127], v244 offset:30720
    v_mul_f32_e32 v209, v209, v252
    v_mfma_f32_16x16x32_bf16 v[212:215], a[144:147], v[176:179], v[212:215]
    v_permlane16_swap_b32_e32 v192, v194
    v_mfma_f32_16x16x32_bf16 v[212:215], a[148:151], v[180:183], v[212:215]
    v_permlane16_swap_b32_e32 v193, v195
    v_mfma_f32_16x16x32_bf16 v[212:215], a[152:155], v[184:187], v[212:215]
    buffer_store_dwordx4 v[192:195], v247, s[16:19], 0 offen offset:256 sc0 sc1
    v_mfma_f32_16x16x32_bf16 v[212:215], a[156:159], v[188:191], v[212:215]
    s_waitcnt lgkmcnt(0)
    v_xor_b32_e32 v244, 0x20, v244
    v_mul_f32_e32 v210, v210, v252
    v_mfma_f32_16x16x32_bf16 v[216:219], a[96:99], v[32:35], v[216:219]
    buffer_store_dwordx4 a[196:199], v247, s[20:23], 0 offen offset:64 sc0 sc1
    v_mfma_f32_16x16x32_bf16 v[216:219], a[100:103], v[36:39], v[216:219]
    ds_read_b64_tr_b16 a[128:129], v244 offset:0
    v_mul_f32_e32 v211, v211, v252
    v_mfma_f32_16x16x32_bf16 v[216:219], a[104:107], v[40:43], v[216:219]
    ds_read_b64_tr_b16 a[130:131], v244 offset:2048
    v_cvt_pk_bf16_f32 v198, v208, v209
    v_mfma_f32_16x16x32_bf16 v[216:219], a[108:111], v[44:47], v[216:219]
    ds_read_b64_tr_b16 a[132:133], v244 offset:4096
    v_cvt_pk_bf16_f32 v199, v210, v211
    v_mfma_f32_16x16x32_bf16 v[216:219], a[112:115], v[48:51], v[216:219]
    ds_read_b64_tr_b16 a[134:135], v244 offset:6144
    v_mul_f32_e32 v212, v212, v253
    v_mfma_f32_16x16x32_bf16 v[216:219], a[116:119], v[52:55], v[216:219]
    v_permlane16_swap_b32_e32 v196, v198
    v_mfma_f32_16x16x32_bf16 v[216:219], a[120:123], v[56:59], v[216:219]
    ds_read_b64_tr_b16 a[136:137], v244 offset:8192
    v_mul_f32_e32 v213, v213, v253
    v_mfma_f32_16x16x32_bf16 v[216:219], a[124:127], v[60:63], v[216:219]
    ds_read_b64_tr_b16 a[138:139], v244 offset:10240
    v_mul_f32_e32 v214, v214, v253
    v_mfma_f32_16x16x32_bf16 v[220:223], a[124:127], v[124:127], v[220:223]
    ds_read_b64_tr_b16 a[140:141], v244 offset:12288
    v_mul_f32_e32 v215, v215, v253
    v_mfma_f32_16x16x32_bf16 v[220:223], a[120:123], v[120:123], v[220:223]
    ds_read_b64_tr_b16 a[142:143], v244 offset:14336
    v_cvt_pk_bf16_f32 v202, v212, v213
    v_mfma_f32_16x16x32_bf16 v[220:223], a[116:119], v[116:119], v[220:223]
    v_permlane16_swap_b32_e32 v197, v199
    v_mfma_f32_16x16x32_bf16 v[220:223], a[112:115], v[112:115], v[220:223]
    ds_read_b64_tr_b16 a[144:145], v244 offset:16384
    v_cvt_pk_bf16_f32 v203, v214, v215
    v_mfma_f32_16x16x32_bf16 v[220:223], a[108:111], v[108:111], v[220:223]
    ds_read_b64_tr_b16 a[146:147], v244 offset:18432
    v_mul_f32_e32 v216, v216, v251
    v_mfma_f32_16x16x32_bf16 v[220:223], a[104:107], v[104:107], v[220:223]
    ds_read_b64_tr_b16 a[148:149], v244 offset:20480
    v_mul_f32_e32 v217, v217, v251
    v_mfma_f32_16x16x32_bf16 v[220:223], a[100:103], v[100:103], v[220:223]
    ds_read_b64_tr_b16 a[150:151], v244 offset:22528
    v_mul_f32_e32 v218, v218, v251
    v_mfma_f32_16x16x32_bf16 v[220:223], a[96:99], v[96:99], v[220:223]
    buffer_store_dwordx4 v[196:199], v247, s[16:19], s45 offen offset:256 sc0 sc1
    v_mfma_f32_16x16x32_bf16 v[224:227], a[96:99], v[160:163], v[224:227]
    ds_read_b64_tr_b16 a[152:153], v244 offset:24576
    v_mul_f32_e32 v219, v219, v251
    v_mfma_f32_16x16x32_bf16 v[224:227], a[100:103], v[164:167], v[224:227]
    ds_read_b64_tr_b16 a[154:155], v244 offset:26624
    v_cvt_pk_bf16_f32 v216, v216, v217
    v_mfma_f32_16x16x32_bf16 v[224:227], a[104:107], v[168:171], v[224:227]
    ds_read_b64_tr_b16 a[156:157], v244 offset:28672
    v_cvt_pk_bf16_f32 v217, v218, v219
    v_mfma_f32_16x16x32_bf16 v[224:227], a[108:111], v[172:175], v[224:227]
    ds_read_b64_tr_b16 a[158:159], v244 offset:30720
    v_mul_f32_e32 v220, v220, v252
    v_mfma_f32_16x16x32_bf16 v[224:227], a[112:115], v[176:179], v[224:227]
    v_permlane16_swap_b32_e32 v200, v202
    v_mfma_f32_16x16x32_bf16 v[224:227], a[116:119], v[180:183], v[224:227]
    v_permlane16_swap_b32_e32 v201, v203
    v_mfma_f32_16x16x32_bf16 v[224:227], a[120:123], v[184:187], v[224:227]
    buffer_store_dwordx4 v[200:203], v247, s[20:23], 0 offen offset:256 sc0 sc1
    v_mfma_f32_16x16x32_bf16 v[224:227], a[124:127], v[188:191], v[224:227]
    s_waitcnt lgkmcnt(0)
    v_xor_b32_e32 v244, 0x38060, v244
    v_mul_f32_e32 v221, v221, v252
    v_mfma_f32_16x16x32_bf16 v[228:231], a[128:131], v[32:35], v[228:231]
    v_mul_f32_e32 v222, v222, v252
    v_mul_f32_e32 v223, v223, v252
    v_mfma_f32_16x16x32_bf16 v[228:231], a[132:135], v[36:39], v[228:231]
    ds_read_b64_tr_b16 a[96:97], v244 offset:0
    v_cvt_pk_bf16_f32 v220, v220, v221
    v_mfma_f32_16x16x32_bf16 v[228:231], a[136:139], v[40:43], v[228:231]
    ds_read_b64_tr_b16 a[98:99], v244 offset:2048
    v_cvt_pk_bf16_f32 v221, v222, v223
    v_mfma_f32_16x16x32_bf16 v[228:231], a[140:143], v[44:47], v[228:231]
    ds_read_b64_tr_b16 a[100:101], v244 offset:4096
    v_mul_f32_e32 v224, v224, v253
    v_mfma_f32_16x16x32_bf16 v[228:231], a[144:147], v[48:51], v[228:231]
    ds_read_b64_tr_b16 a[102:103], v244 offset:6144
    v_mul_f32_e32 v225, v225, v253
    v_mfma_f32_16x16x32_bf16 v[228:231], a[148:151], v[52:55], v[228:231]
    v_mul_f32_e32 v226, v226, v253
    v_mul_f32_e32 v227, v227, v253
    v_mfma_f32_16x16x32_bf16 v[228:231], a[152:155], v[56:59], v[228:231]
    ds_read_b64_tr_b16 a[104:105], v244 offset:8192
    v_cvt_pk_bf16_f32 v224, v224, v225
    v_mfma_f32_16x16x32_bf16 v[228:231], a[156:159], v[60:63], v[228:231]
    ds_read_b64_tr_b16 a[106:107], v244 offset:10240
    v_cvt_pk_bf16_f32 v225, v226, v227
    v_mfma_f32_16x16x32_bf16 v[232:235], a[156:159], v[124:127], v[232:235]
    ds_read_b64_tr_b16 a[108:109], v244 offset:12288
    v_mfma_f32_16x16x32_bf16 v[232:235], a[152:155], v[120:123], v[232:235]
    ds_read_b64_tr_b16 a[110:111], v244 offset:14336
    v_mfma_f32_16x16x32_bf16 v[232:235], a[148:151], v[116:119], v[232:235]
    v_mfma_f32_16x16x32_bf16 v[232:235], a[144:147], v[112:115], v[232:235]
    ds_read_b64_tr_b16 a[112:113], v244 offset:16384
    v_mul_f32_e32 v228, v228, v251
    v_mfma_f32_16x16x32_bf16 v[232:235], a[140:143], v[108:111], v[232:235]
    ds_read_b64_tr_b16 a[114:115], v244 offset:18432
    v_mul_f32_e32 v229, v229, v251
    v_mfma_f32_16x16x32_bf16 v[232:235], a[136:139], v[104:107], v[232:235]
    ds_read_b64_tr_b16 a[116:117], v244 offset:20480
    v_mul_f32_e32 v230, v230, v251
    v_mfma_f32_16x16x32_bf16 v[232:235], a[132:135], v[100:103], v[232:235]
    ds_read_b64_tr_b16 a[118:119], v244 offset:22528
    v_mul_f32_e32 v231, v231, v251
    v_mfma_f32_16x16x32_bf16 v[232:235], a[128:131], v[96:99], v[232:235]
    v_cvt_pk_bf16_f32 v218, v228, v229
    v_cvt_pk_bf16_f32 v219, v230, v231
    v_mfma_f32_16x16x32_bf16 v[236:239], a[128:131], v[160:163], v[236:239]
    ds_read_b64_tr_b16 a[120:121], v244 offset:24576
    v_mfma_f32_16x16x32_bf16 v[236:239], a[132:135], v[164:167], v[236:239]
    ds_read_b64_tr_b16 a[122:123], v244 offset:26624
    v_mfma_f32_16x16x32_bf16 v[236:239], a[136:139], v[168:171], v[236:239]
    ds_read_b64_tr_b16 a[124:125], v244 offset:28672
    v_mul_f32_e32 v232, v232, v252
    v_mfma_f32_16x16x32_bf16 v[236:239], a[140:143], v[172:175], v[236:239]
    ds_read_b64_tr_b16 a[126:127], v244 offset:30720
    v_mul_f32_e32 v233, v233, v252
    v_mfma_f32_16x16x32_bf16 v[236:239], a[144:147], v[176:179], v[236:239]
    v_permlane16_swap_b32_e32 v216, v218
    v_mfma_f32_16x16x32_bf16 v[236:239], a[148:151], v[180:183], v[236:239]
    v_permlane16_swap_b32_e32 v217, v219
    v_mfma_f32_16x16x32_bf16 v[236:239], a[152:155], v[184:187], v[236:239]
    buffer_store_dwordx4 v[216:219], v247, s[16:19], 0 offen offset:320 sc0 sc1
    v_mfma_f32_16x16x32_bf16 v[236:239], a[156:159], v[188:191], v[236:239]
    s_waitcnt lgkmcnt(0)
    v_xor_b32_e32 v244, 0x20, v244
    v_mul_f32_e32 v234, v234, v252
    v_mfma_f32_16x16x32_bf16 v[192:195], a[96:99], v[0:3], 0
    v_mul_f32_e32 v235, v235, v252
    v_cvt_pk_bf16_f32 v222, v232, v233
    v_mfma_f32_16x16x32_bf16 v[192:195], a[100:103], v[4:7], v[192:195]
    ds_read_b64_tr_b16 a[128:129], v244 offset:0
    v_cvt_pk_bf16_f32 v223, v234, v235
    v_mfma_f32_16x16x32_bf16 v[192:195], a[104:107], v[8:11], v[192:195]
    ds_read_b64_tr_b16 a[130:131], v244 offset:2048
    v_mul_f32_e32 v236, v236, v253
    v_mfma_f32_16x16x32_bf16 v[192:195], a[108:111], v[12:15], v[192:195]
    ds_read_b64_tr_b16 a[132:133], v244 offset:4096
    v_mul_f32_e32 v237, v237, v253
    v_mfma_f32_16x16x32_bf16 v[192:195], a[112:115], v[16:19], v[192:195]
    ds_read_b64_tr_b16 a[134:135], v244 offset:6144
    v_mul_f32_e32 v238, v238, v253
    v_mfma_f32_16x16x32_bf16 v[192:195], a[116:119], v[20:23], v[192:195]
    v_permlane16_swap_b32_e32 v220, v222
    v_mfma_f32_16x16x32_bf16 v[192:195], a[120:123], v[24:27], v[192:195]
    ds_read_b64_tr_b16 a[136:137], v244 offset:8192
    v_mul_f32_e32 v239, v239, v253
L_walk3:
L_pad6:
    s_cbranch_vccnz L_pad7
    v_mfma_f32_16x16x32_bf16 v[192:195], a[124:127], v[28:31], v[192:195]
    ds_read_b64_tr_b16 a[138:139], v244 offset:10240
    v_cvt_pk_bf16_f32 v226, v236, v237
    v_mfma_f32_16x16x32_bf16 v[196:199], a[124:127], v[92:95], 0
    ds_read_b64_tr_b16 a[140:141], v244 offset:12288
    v_cvt_pk_bf16_f32 v227, v238, v239
    v_mfma_f32_16x16x32_bf16 v[196:199], a[120:123], v[88:91], v[196:199]
    ds_read_b64_tr_b16 a[142:143], v244 offset:14336
    v_mfma_f32_16x16x32_bf16 v[196:199], a[116:119], v[84:87], v[196:199]
    v_permlane16_swap_b32_e32 v221, v223
    v_mfma_f32_16x16x32_bf16 v[196:199], a[112:115], v[80:83], v[196:199]
    ds_read_b64_tr_b16 a[144:145], v244 offset:16384
    v_mfma_f32_16x16x32_bf16 v[196:199], a[108:111], v[76:79], v[196:199]
    ds_read_b64_tr_b16 a[146:147], v244 offset:18432
    v_mfma_f32_16x16x32_bf16 v[196:199], a[104:107], v[72:75], v[196:199]
    ds_read_b64_tr_b16 a[148:149], v244 offset:20480
    v_mfma_f32_16x16x32_bf16 v[196:199], a[100:103], v[68:71], v[196:199]
    ds_read_b64_tr_b16 a[150:151], v244 offset:22528
    v_mfma_f32_16x16x32_bf16 v[196:199], a[96:99], v[64:67], v[196:199]
    buffer_store_dwordx4 v[220:223], v247, s[16:19], s45 offen offset:320 sc0 sc1
    v_mfma_f32_16x16x32_bf16 v[200:203], a[96:99], v[128:131], 0
    ds_read_b64_tr_b16 a[152:153], v244 offset:24576
    v_mfma_f32_16x16x32_bf16 v[200:203], a[100:103], v[132:135], v[200:203]
    ds_read_b64_tr_b16 a[154:155], v244 offset:26624
    v_mfma_f32_16x16x32_bf16 v[200:203], a[104:107], v[136:139], v[200:203]
    ds_read_b64_tr_b16 a[156:157], v244 offset:28672
    v_mfma_f32_16x16x32_bf16 v[200:203], a[108:111], v[140:143], v[200:203]
    ds_read_b64_tr_b16 a[158:159], v244 offset:30720
    v_mfma_f32_16x16x32_bf16 v[200:203], a[112:115], v[144:147], v[200:203]
    v_permlane16_swap_b32_e32 v224, v226
    v_mfma_f32_16x16x32_bf16 v[200:203], a[116:119], v[148:151], v[200:203]
    v_permlane16_swap_b32_e32 v225, v227
    v_mfma_f32_16x16x32_bf16 v[200:203], a[120:123], v[152:155], v[200:203]
    buffer_store_dwordx4 v[224:227], v247, s[20:23], 0 offen offset:320 sc0 sc1
    v_mfma_f32_16x16x32_bf16 v[200:203], a[124:127], v[156:159], v[200:203]
    s_waitcnt lgkmcnt(0)
    v_xor_b32_e32 v244, 0x20020, v244
    v_mfma_f32_16x16x32_bf16 v[204:207], a[128:131], v[0:3], 0
    v_mfma_f32_16x16x32_bf16 v[204:207], a[132:135], v[4:7], v[204:207]
    ds_read_b64_tr_b16 a[96:97], v244 offset:0
    v_mfma_f32_16x16x32_bf16 v[204:207], a[136:139], v[8:11], v[204:207]
    ds_read_b64_tr_b16 a[98:99], v244 offset:2048
    v_mfma_f32_16x16x32_bf16 v[204:207], a[140:143], v[12:15], v[204:207]
    ds_read_b64_tr_b16 a[100:101], v244 offset:4096
    v_mfma_f32_16x16x32_bf16 v[204:207], a[144:147], v[16:19], v[204:207]
    ds_read_b64_tr_b16 a[102:103], v244 offset:6144
    v_mfma_f32_16x16x32_bf16 v[204:207], a[148:151], v[20:23], v[204:207]
    v_mfma_f32_16x16x32_bf16 v[204:207], a[152:155], v[24:27], v[204:207]
    ds_read_b64_tr_b16 a[104:105], v244 offset:8192
    v_mfma_f32_16x16x32_bf16 v[204:207], a[156:159], v[28:31], v[204:207]
    ds_read_b64_tr_b16 a[106:107], v244 offset:10240
    v_mfma_f32_16x16x32_bf16 v[208:211], a[156:159], v[92:95], 0
    ds_read_b64_tr_b16 a[108:109], v244 offset:12288
    v_mfma_f32_16x16x32_bf16 v[208:211], a[152:155], v[88:91], v[208:211]
    ds_read_b64_tr_b16 a[110:111], v244 offset:14336
    v_mfma_f32_16x16x32_bf16 v[208:211], a[148:151], v[84:87], v[208:211]
    buffer_store_dwordx4 a[200:203], v247, s[16:19], 0 offen offset:128 sc0 sc1
    v_mfma_f32_16x16x32_bf16 v[208:211], a[144:147], v[80:83], v[208:211]
    ds_read_b64_tr_b16 a[112:113], v244 offset:16384
    v_mfma_f32_16x16x32_bf16 v[208:211], a[140:143], v[76:79], v[208:211]
    ds_read_b64_tr_b16 a[114:115], v244 offset:18432
    v_mfma_f32_16x16x32_bf16 v[208:211], a[136:139], v[72:75], v[208:211]
    ds_read_b64_tr_b16 a[116:117], v244 offset:20480
    v_mfma_f32_16x16x32_bf16 v[208:211], a[132:135], v[68:71], v[208:211]
    ds_read_b64_tr_b16 a[118:119], v244 offset:22528
    v_mfma_f32_16x16x32_bf16 v[208:211], a[128:131], v[64:67], v[208:211]
    v_mfma_f32_16x16x32_bf16 v[212:215], a[128:131], v[128:131], 0
    ds_read_b64_tr_b16 a[120:121], v244 offset:24576
    v_mfma_f32_16x16x32_bf16 v[212:215], a[132:135], v[132:135], v[212:215]
    ds_read_b64_tr_b16 a[122:123], v244 offset:26624
    v_mfma_f32_16x16x32_bf16 v[212:215], a[136:139], v[136:139], v[212:215]
    ds_read_b64_tr_b16 a[124:125], v244 offset:28672
    v_mfma_f32_16x16x32_bf16 v[212:215], a[140:143], v[140:143], v[212:215]
    ds_read_b64_tr_b16 a[126:127], v244 offset:30720
    v_mfma_f32_16x16x32_bf16 v[212:215], a[144:147], v[144:147], v[212:215]
    v_mfma_f32_16x16x32_bf16 v[212:215], a[148:151], v[148:151], v[212:215]
    v_mfma_f32_16x16x32_bf16 v[212:215], a[152:155], v[152:155], v[212:215]
    v_mfma_f32_16x16x32_bf16 v[212:215], a[156:159], v[156:159], v[212:215]
    s_waitcnt lgkmcnt(0)
    v_xor_b32_e32 v244, 0x20, v244
    v_mfma_f32_16x16x32_bf16 v[192:195], a[96:99], v[32:35], v[192:195]
    buffer_store_dwordx4 a[204:207], v247, s[16:19], s45 offen offset:128 sc0 sc1
    v_mfma_f32_16x16x32_bf16 v[192:195], a[100:103], v[36:39], v[192:195]
    ds_read_b64_tr_b16 a[128:129], v244 offset:0
    v_mfma_f32_16x16x32_bf16 v[192:195], a[104:107], v[40:43], v[192:195]
    ds_read_b64_tr_b16 a[130:131], v244 offset:2048
    v_mfma_f32_16x16x32_bf16 v[192:195], a[108:111], v[44:47], v[192:195]
    ds_read_b64_tr_b16 a[132:133], v244 offset:4096
    v_mfma_f32_16x16x32_bf16 v[192:195], a[112:115], v[48:51], v[192:195]
    ds_read_b64_tr_b16 a[134:135], v244 offset:6144
    v_mfma_f32_16x16x32_bf16 v[192:195], a[116:119], v[52:55], v[192:195]
    v_mfma_f32_16x16x32_bf16 v[192:195], a[120:123], v[56:59], v[192:195]
    ds_read_b64_tr_b16 a[136:137], v244 offset:8192
    v_mfma_f32_16x16x32_bf16 v[192:195], a[124:127], v[60:63], v[192:195]
    ds_read_b64_tr_b16 a[138:139], v244 offset:10240
    v_mfma_f32_16x16x32_bf16 v[196:199], a[124:127], v[124:127], v[196:199]
    ds_read_b64_tr_b16 a[140:141], v244 offset:12288
    v_mfma_f32_16x16x32_bf16 v[196:199], a[120:123], v[120:123], v[196:199]
    ds_read_b64_tr_b16 a[142:143], v244 offset:14336
    v_mfma_f32_16x16x32_bf16 v[196:199], a[116:119], v[116:119], v[196:199]
    v_mfma_f32_16x16x32_bf16 v[196:199], a[112:115], v[112:115], v[196:199]
    ds_read_b64_tr_b16 a[144:145], v244 offset:16384
    v_mul_f32_e32 v192, v192, v251
    v_mfma_f32_16x16x32_bf16 v[196:199], a[108:111], v[108:111], v[196:199]
    ds_read_b64_tr_b16 a[146:147], v244 offset:18432
    v_mul_f32_e32 v193, v193, v251
    v_mfma_f32_16x16x32_bf16 v[196:199], a[104:107], v[104:107], v[196:199]
    ds_read_b64_tr_b16 a[148:149], v244 offset:20480
    v_mul_f32_e32 v194, v194, v251
    v_mfma_f32_16x16x32_bf16 v[196:199], a[100:103], v[100:103], v[196:199]
    ds_read_b64_tr_b16 a[150:151], v244 offset:22528
    v_mul_f32_e32 v195, v195, v251
    v_mfma_f32_16x16x32_bf16 v[196:199], a[96:99], v[96:99], v[196:199]
    buffer_store_dwordx4 a[208:211], v247, s[20:23], 0 offen offset:128 sc0 sc1
    v_mfma_f32_16x16x32_bf16 v[200:203], a[96:99], v[160:163], v[200:203]
    ds_read_b64_tr_b16 a[152:153], v244 offset:24576
    v_cvt_pk_bf16_f32 v192, v192, v193
    v_mfma_f32_16x16x32_bf16 v[200:203], a[100:103], v[164:167], v[200:203]
    ds_read_b64_tr_b16 a[154:155], v244 offset:26624
    v_cvt_pk_bf16_f32 v193, v194, v195
    v_mfma_f32_16x16x32_bf16 v[200:203], a[104:107], v[168:171], v[200:203]
    ds_read_b64_tr_b16 a[156:157], v244 offset:28672
    v_mul_f32_e32 v196, v196, v252
    v_mfma_f32_16x16x32_bf16 v[200:203], a[108:111], v[172:175], v[200:203]
    ds_read_b64_tr_b16 a[158:159], v244 offset:30720
    v_mul_f32_e32 v197, v197, v252
    v_mfma_f32_16x16x32_bf16 v[200:203], a[112:115], v[176:179], v[200:203]
    v_mul_f32_e32 v198, v198, v252
    v_mul_f32_e32 v199, v199, v252
    v_mfma_f32_16x16x32_bf16 v[200:203], a[116:119], v[180:183], v[200:203]
    v_cvt_pk_bf16_f32 v196, v196, v197
    v_cvt_pk_bf16_f32 v197, v198, v199
    v_mfma_f32_16x16x32_bf16 v[200:203], a[120:123], v[184:187], v[200:203]
    v_mfma_f32_16x16x32_bf16 v[200:203], a[124:127], v[188:191], v[200:203]
    s_waitcnt lgkmcnt(0)
    v_xor_b32_e32 v244, 0x20060, v244
    v_mfma_f32_16x16x32_bf16 v[204:207], a[128:131], v[32:35], v[204:207]
    v_mfma_f32_16x16x32_bf16 v[204:207], a[132:135], v[36:39], v[204:207]
    ds_read_b64_tr_b16 a[96:97], v244 offset:0
    v_mfma_f32_16x16x32_bf16 v[204:207], a[136:139], v[40:43], v[204:207]
    ds_read_b64_tr_b16 a[98:99], v244 offset:2048
    v_mfma_f32_16x16x32_bf16 v[204:207], a[140:143], v[44:47], v[204:207]
    ds_read_b64_tr_b16 a[100:101], v244 offset:4096
    v_mul_f32_e32 v200, v200, v253
    v_mfma_f32_16x16x32_bf16 v[204:207], a[144:147], v[48:51], v[204:207]
    ds_read_b64_tr_b16 a[102:103], v244 offset:6144
    v_mul_f32_e32 v201, v201, v253
    v_mfma_f32_16x16x32_bf16 v[204:207], a[148:151], v[52:55], v[204:207]
    v_mul_f32_e32 v202, v202, v253
    v_mul_f32_e32 v203, v203, v253
    v_mfma_f32_16x16x32_bf16 v[204:207], a[152:155], v[56:59], v[204:207]
    ds_read_b64_tr_b16 a[104:105], v244 offset:8192
    v_cvt_pk_bf16_f32 v200, v200, v201
    v_mfma_f32_16x16x32_bf16 v[204:207], a[156:159], v[60:63], v[204:207]
    ds_read_b64_tr_b16 a[106:107], v244 offset:10240
    v_cvt_pk_bf16_f32 v201, v202, v203
    v_mfma_f32_16x16x32_bf16 v[208:211], a[156:159], v[124:127], v[208:211]
    ds_read_b64_tr_b16 a[108:109], v244 offset:12288
    v_mfma_f32_16x16x32_bf16 v[208:211], a[152:155], v[120:123], v[208:211]
    ds_read_b64_tr_b16 a[110:111], v244 offset:14336
    v_mfma_f32_16x16x32_bf16 v[208:211], a[148:151], v[116:119], v[208:211]
    buffer_store_dwordx4 a[212:215], v247, s[16:19], 0 offen offset:192 sc0 sc1
    v_mfma_f32_16x16x32_bf16 v[208:211], a[144:147], v[112:115], v[208:211]
    ds_read_b64_tr_b16 a[112:113], v244 offset:16384
    v_mul_f32_e32 v204, v204, v251
    v_mfma_f32_16x16x32_bf16 v[208:211], a[140:143], v[108:111], v[208:211]
    ds_read_b64_tr_b16 a[114:115], v244 offset:18432
    v_mul_f32_e32 v205, v205, v251
    v_mfma_f32_16x16x32_bf16 v[208:211], a[136:139], v[104:107], v[208:211]
    ds_read_b64_tr_b16 a[116:117], v244 offset:20480
    v_mul_f32_e32 v206, v206, v251
    v_mfma_f32_16x16x32_bf16 v[208:211], a[132:135], v[100:103], v[208:211]
    ds_read_b64_tr_b16 a[118:119], v244 offset:22528
    v_mul_f32_e32 v207, v207, v251
    v_mfma_f32_16x16x32_bf16 v[208:211], a[128:131], v[96:99], v[208:211]
    v_cvt_pk_bf16_f32 v194, v204, v205
    v_cvt_pk_bf16_f32 v195, v206, v207
    v_mfma_f32_16x16x32_bf16 v[212:215], a[128:131], v[160:163], v[212:215]
    ds_read_b64_tr_b16 a[120:121], v244 offset:24576
    v_mfma_f32_16x16x32_bf16 v[212:215], a[132:135], v[164:167], v[212:215]
    ds_read_b64_tr_b16 a[122:123], v244 offset:26624
    v_mfma_f32_16x16x32_bf16 v[212:215], a[136:139], v[168:171], v[212:215]
    ds_read_b64_tr_b16 a[124:125], v244 offset:28672
    v_mul_f32_e32 v208, v208, v252
    v_mfma_f32_16x16x32_bf16 v[212:215], a[140:143], v[172:175], v[212:215]
    ds_read_b64_tr_b16 a[126:127], v244 offset:30720
    v_mul_f32_e32 v209, v209, v252
    v_mfma_f32_16x16x32_bf16 v[212:215], a[144:147], v[176:179], v[212:215]
    v_permlane16_swap_b32_e32 v192, v194
    v_mfma_f32_16x16x32_bf16 v[212:215], a[148:151], v[180:183], v[212:215]
    v_permlane16_swap_b32_e32 v193, v195
    v_mfma_f32_16x16x32_bf16 v[212:215], a[152:155], v[184:187], v[212:215]
    buffer_store_dwordx4 v[192:195], v247, s[16:19], 0 offen offset:384 sc0 sc1
    v_mfma_f32_16x16x32_bf16 v[212:215], a[156:159], v[188:191], v[212:215]
    s_waitcnt lgkmcnt(0)
    v_xor_b32_e32 v244, 0x20, v244
    v_mul_f32_e32 v210, v210, v252
    v_mfma_f32_16x16x32_bf16 v[216:219], a[96:99], v[0:3], 0
    v_mul_f32_e32 v211, v211, v252
    v_cvt_pk_bf16_f32 v198, v208, v209
    v_mfma_f32_16x16x32_bf16 v[216:219], a[100:103], v[4:7], v[216:219]
    ds_read_b64_tr_b16 a[128:129], v244 offset:0
    v_cvt_pk_bf16_f32 v199, v210, v211
    v_mfma_f32_16x16x32_bf16 v[216:219], a[104:107], v[8:11], v[216:219]
    ds_read_b64_tr_b16 a[130:131], v244 offset:2048
    v_mul_f32_e32 v212, v212, v253
    v_mfma_f32_16x16x32_bf16 v[216:219], a[108:111], v[12:15], v[216:219]
    ds_read_b64_tr_b16 a[132:133], v244 offset:4096
    v_mul_f32_e32 v213, v213, v253
    v_mfma_f32_16x16x32_bf16 v[216:219], a[112:115], v[16:19], v[216:219]
    ds_read_b64_tr_b16 a[134:135], v244 offset:6144
    v_mul_f32_e32 v214, v214, v253
    v_mfma_f32_16x16x32_bf16 v[216:219], a[116:119], v[20:23], v[216:219]
    v_permlane16_swap_b32_e32 v196, v198
    v_mfma_f32_16x16x32_bf16 v[216:219], a[120:123], v[24:27], v[216:219]
    ds_read_b64_tr_b16 a[136:137], v244 offset:8192
    v_mul_f32_e32 v215, v215, v253
    v_mfma_f32_16x16x32_bf16 v[216:219], a[124:127], v[28:31], v[216:219]
    ds_read_b64_tr_b16 a[138:139], v244 offset:10240
    v_cvt_pk_bf16_f32 v202, v212, v213
    v_mfma_f32_16x16x32_bf16 v[220:223], a[124:127], v[92:95], 0
    ds_read_b64_tr_b16 a[140:141], v244 offset:12288
    v_cvt_pk_bf16_f32 v203, v214, v215
    v_mfma_f32_16x16x32_bf16 v[220:223], a[120:123], v[88:91], v[220:223]
    ds_read_b64_tr_b16 a[142:143], v244 offset:14336
    v_mfma_f32_16x16x32_bf16 v[220:223], a[116:119], v[84:87], v[220:223]
    v_permlane16_swap_b32_e32 v197, v199
    v_mfma_f32_16x16x32_bf16 v[220:223], a[112:115], v[80:83], v[220:223]
    ds_read_b64_tr_b16 a[144:145], v244 offset:16384
    v_mfma_f32_16x16x32_bf16 v[220:223], a[108:111], v[76:79], v[220:223]
    ds_read_b64_tr_b16 a[146:147], v244 offset:18432
    v_mfma_f32_16x16x32_bf16 v[220:223], a[104:107], v[72:75], v[220:223]
    ds_read_b64_tr_b16 a[148:149], v244 offset:20480
    v_mfma_f32_16x16x32_bf16 v[220:223], a[100:103], v[68:71], v[220:223]
    ds_read_b64_tr_b16 a[150:151], v244 offset:22528
    v_mfma_f32_16x16x32_bf16 v[220:223], a[96:99], v[64:67], v[220:223]
    buffer_store_dwordx4 v[196:199], v247, s[16:19], s45 offen offset:384 sc0 sc1
    v_mfma_f32_16x16x32_bf16 v[224:227], a[96:99], v[128:131], 0
    ds_read_b64_tr_b16 a[152:153], v244 offset:24576
    v_mfma_f32_16x16x32_bf16 v[224:227], a[100:103], v[132:135], v[224:227]
    ds_read_b64_tr_b16 a[154:155], v244 offset:26624
    v_mfma_f32_16x16x32_bf16 v[224:227], a[104:107], v[136:139], v[224:227]
    ds_read_b64_tr_b16 a[156:157], v244 offset:28672
    v_mfma_f32_16x16x32_bf16 v[224:227], a[108:111], v[140:143], v[224:227]
    ds_read_b64_tr_b16 a[158:159], v244 offset:30720
    v_mfma_f32_16x16x32_bf16 v[224:227], a[112:115], v[144:147], v[224:227]
    v_permlane16_swap_b32_e32 v200, v202
    v_mfma_f32_16x16x32_bf16 v[224:227], a[116:119], v[148:151], v[224:227]
    v_permlane16_swap_b32_e32 v201, v203
    v_mfma_f32_16x16x32_bf16 v[224:227], a[120:123], v[152:155], v[224:227]
    buffer_store_dwordx4 v[200:203], v247, s[20:23], 0 offen offset:384 sc0 sc1
    v_mfma_f32_16x16x32_bf16 v[224:227], a[124:127], v[156:159], v[224:227]
    s_waitcnt lgkmcnt(0)
    v_xor_b32_e32 v244, 0x20020, v244
    v_mfma_f32_16x16x32_bf16 v[228:231], a[128:131], v[0:3], 0
    buffer_store_dwordx4 a[216:219], v247, s[16:19], s45 offen offset:192 sc0 sc1
    v_mfma_f32_16x16x32_bf16 v[228:231], a[132:135], v[4:7], v[228:231]
    ds_read_b64_tr_b16 a[96:97], v244 offset:0
    v_mfma_f32_16x16x32_bf16 v[228:231], a[136:139], v[8:11], v[228:231]
    ds_read_b64_tr_b16 a[98:99], v244 offset:2048
    v_mfma_f32_16x16x32_bf16 v[228:231], a[140:143], v[12:15], v[228:231]
    ds_read_b64_tr_b16 a[100:101], v244 offset:4096
    v_mfma_f32_16x16x32_bf16 v[228:231], a[144:147], v[16:19], v[228:231]
    ds_read_b64_tr_b16 a[102:103], v244 offset:6144
    v_mfma_f32_16x16x32_bf16 v[228:231], a[148:151], v[20:23], v[228:231]
    v_mfma_f32_16x16x32_bf16 v[228:231], a[152:155], v[24:27], v[228:231]
    ds_read_b64_tr_b16 a[104:105], v244 offset:8192
    v_mfma_f32_16x16x32_bf16 v[228:231], a[156:159], v[28:31], v[228:231]
    ds_read_b64_tr_b16 a[106:107], v244 offset:10240
    v_mfma_f32_16x16x32_bf16 v[232:235], a[156:159], v[92:95], 0
    ds_read_b64_tr_b16 a[108:109], v244 offset:12288
    v_mfma_f32_16x16x32_bf16 v[232:235], a[152:155], v[88:91], v[232:235]
    ds_read_b64_tr_b16 a[110:111], v244 offset:14336
    v_mfma_f32_16x16x32_bf16 v[232:235], a[148:151], v[84:87], v[232:235]
    v_mfma_f32_16x16x32_bf16 v[232:235], a[144:147], v[80:83], v[232:235]
    ds_read_b64_tr_b16 a[112:113], v244 offset:16384
    v_mfma_f32_16x16x32_bf16 v[232:235], a[140:143], v[76:79], v[232:235]
    ds_read_b64_tr_b16 a[114:115], v244 offset:18432
    v_mfma_f32_16x16x32_bf16 v[232:235], a[136:139], v[72:75], v[232:235]
    ds_read_b64_tr_b16 a[116:117], v244 offset:20480
    v_mfma_f32_16x16x32_bf16 v[232:235], a[132:135], v[68:71], v[232:235]
    ds_read_b64_tr_b16 a[118:119], v244 offset:22528
    v_mfma_f32_16x16x32_bf16 v[232:235], a[128:131], v[64:67], v[232:235]
    v_mfma_f32_16x16x32_bf16 v[236:239], a[128:131], v[128:131], 0
    ds_read_b64_tr_b16 a[120:121], v244 offset:24576
    v_mfma_f32_16x16x32_bf16 v[236:239], a[132:135], v[132:135], v[236:239]
    ds_read_b64_tr_b16 a[122:123], v244 offset:26624
    v_mfma_f32_16x16x32_bf16 v[236:239], a[136:139], v[136:139], v[236:239]
    ds_read_b64_tr_b16 a[124:125], v244 offset:28672
    v_mfma_f32_16x16x32_bf16 v[236:239], a[140:143], v[140:143], v[236:239]
    ds_read_b64_tr_b16 a[126:127], v244 offset:30720
    v_mfma_f32_16x16x32_bf16 v[236:239], a[144:147], v[144:147], v[236:239]
    buffer_store_dwordx4 a[220:223], v247, s[20:23], 0 offen offset:192 sc0 sc1
    v_mfma_f32_16x16x32_bf16 v[236:239], a[148:151], v[148:151], v[236:239]
    v_mfma_f32_16x16x32_bf16 v[236:239], a[152:155], v[152:155], v[236:239]
    v_mfma_f32_16x16x32_bf16 v[236:239], a[156:159], v[156:159], v[236:239]
    s_waitcnt lgkmcnt(0)
    v_xor_b32_e32 v244, 0x20, v244
    v_mfma_f32_16x16x32_bf16 v[216:219], a[96:99], v[32:35], v[216:219]
    v_mfma_f32_16x16x32_bf16 v[216:219], a[100:103], v[36:39], v[216:219]
    ds_read_b64_tr_b16 a[128:129], v244 offset:0
    v_mfma_f32_16x16x32_bf16 v[216:219], a[104:107], v[40:43], v[216:219]
    ds_read_b64_tr_b16 a[130:131], v244 offset:2048
    v_mfma_f32_16x16x32_bf16 v[216:219], a[108:111], v[44:47], v[216:219]
    ds_read_b64_tr_b16 a[132:133], v244 offset:4096
    v_mfma_f32_16x16x32_bf16 v[216:219], a[112:115], v[48:51], v[216:219]
    ds_read_b64_tr_b16 a[134:135], v244 offset:6144
    v_mfma_f32_16x16x32_bf16 v[216:219], a[116:119], v[52:55], v[216:219]
    v_mfma_f32_16x16x32_bf16 v[216:219], a[120:123], v[56:59], v[216:219]
    ds_read_b64_tr_b16 a[136:137], v244 offset:8192
    v_mfma_f32_16x16x32_bf16 v[216:219], a[124:127], v[60:63], v[216:219]
    ds_read_b64_tr_b16 a[138:139], v244 offset:10240
    v_mfma_f32_16x16x32_bf16 v[220:223], a[124:127], v[124:127], v[220:223]
    ds_read_b64_tr_b16 a[140:141], v244 offset:12288
    v_mfma_f32_16x16x32_bf16 v[220:223], a[120:123], v[120:123], v[220:223]
    ds_read_b64_tr_b16 a[142:143], v244 offset:14336
    v_mfma_f32_16x16x32_bf16 v[220:223], a[116:119], v[116:119], v[220:223]
    v_mfma_f32_16x16x32_bf16 v[220:223], a[112:115], v[112:115], v[220:223]
    ds_read_b64_tr_b16 a[144:145], v244 offset:16384
    v_mul_f32_e32 v216, v216, v251
    v_mfma_f32_16x16x32_bf16 v[220:223], a[108:111], v[108:111], v[220:223]
    ds_read_b64_tr_b16 a[146:147], v244 offset:18432
    v_mul_f32_e32 v217, v217, v251
    v_mfma_f32_16x16x32_bf16 v[220:223], a[104:107], v[104:107], v[220:223]
    ds_read_b64_tr_b16 a[148:149], v244 offset:20480
    v_mul_f32_e32 v218, v218, v251
    v_mfma_f32_16x16x32_bf16 v[220:223], a[100:103], v[100:103], v[220:223]
    ds_read_b64_tr_b16 a[150:151], v244 offset:22528
    v_mul_f32_e32 v219, v219, v251
    v_mfma_f32_16x16x32_bf16 v[220:223], a[96:99], v[96:99], v[220:223]
    v_cvt_pk_bf16_f32 v216, v216, v217
    v_cvt_pk_bf16_f32 v217, v218, v219
    v_mfma_f32_16x16x32_bf16 v[224:227], a[96:99], v[160:163], v[224:227]
    ds_read_b64_tr_b16 a[152:153], v244 offset:24576
    v_mfma_f32_16x16x32_bf16 v[224:227], a[100:103], v[164:167], v[224:227]
    ds_read_b64_tr_b16 a[154:155], v244 offset:26624
    v_mfma_f32_16x16x32_bf16 v[224:227], a[104:107], v[168:171], v[224:227]
    ds_read_b64_tr_b16 a[156:157], v244 offset:28672
    v_mul_f32_e32 v220, v220, v252
    v_mfma_f32_16x16x32_bf16 v[224:227], a[108:111], v[172:175], v[224:227]
    ds_read_b64_tr_b16 a[158:159], v244 offset:30720
    v_mul_f32_e32 v221, v221, v252
    v_mfma_f32_16x16x32_bf16 v[224:227], a[112:115], v[176:179], v[224:227]
    v_mul_f32_e32 v222, v222, v252
    v_mul_f32_e32 v223, v223, v252
    v_mfma_f32_16x16x32_bf16 v[224:227], a[116:119], v[180:183], v[224:227]
    v_cvt_pk_bf16_f32 v220, v220, v221
    v_cvt_pk_bf16_f32 v221, v222, v223
    v_mfma_f32_16x16x32_bf16 v[224:227], a[120:123], v[184:187], v[224:227]
    v_mfma_f32_16x16x32_bf16 v[224:227], a[124:127], v[188:191], v[224:227]
    s_waitcnt lgkmcnt(0)
    s_nop 1
    v_mfma_f32_16x16x32_bf16 v[228:231], a[128:131], v[32:35], v[228:231]
    s_nop 2
    v_mfma_f32_16x16x32_bf16 v[228:231], a[132:135], v[36:39], v[228:231]
    v_mul_f32_e32 v224, v224, v253
    v_mul_f32_e32 v225, v225, v253
    v_mfma_f32_16x16x32_bf16 v[228:231], a[136:139], v[40:43], v[228:231]
    v_mul_f32_e32 v226, v226, v253
    v_mul_f32_e32 v227, v227, v253
    v_mfma_f32_16x16x32_bf16 v[228:231], a[140:143], v[44:47], v[228:231]
    v_cvt_pk_bf16_f32 v224, v224, v225
    v_cvt_pk_bf16_f32 v225, v226, v227
    v_mfma_f32_16x16x32_bf16 v[228:231], a[144:147], v[48:51], v[228:231]
    v_mfma_f32_16x16x32_bf16 v[228:231], a[148:151], v[52:55], v[228:231]
    v_mfma_f32_16x16x32_bf16 v[228:231], a[152:155], v[56:59], v[228:231]
    v_mfma_f32_16x16x32_bf16 v[228:231], a[156:159], v[60:63], v[228:231]
    s_nop 2
    v_mfma_f32_16x16x32_bf16 v[232:235], a[156:159], v[124:127], v[232:235]
    s_nop 2
    v_mfma_f32_16x16x32_bf16 v[232:235], a[152:155], v[120:123], v[232:235]
    v_mul_f32_e32 v228, v228, v251
    v_mul_f32_e32 v229, v229, v251
    v_mfma_f32_16x16x32_bf16 v[232:235], a[148:151], v[116:119], v[232:235]
    v_mul_f32_e32 v230, v230, v251
    v_mul_f32_e32 v231, v231, v251
    v_mfma_f32_16x16x32_bf16 v[232:235], a[144:147], v[112:115], v[232:235]
    v_cvt_pk_bf16_f32 v218, v228, v229
    v_cvt_pk_bf16_f32 v219, v230, v231
    v_mfma_f32_16x16x32_bf16 v[232:235], a[140:143], v[108:111], v[232:235]
    v_mfma_f32_16x16x32_bf16 v[232:235], a[136:139], v[104:107], v[232:235]
    v_permlane16_swap_b32_e32 v216, v218
    v_mfma_f32_16x16x32_bf16 v[232:235], a[132:135], v[100:103], v[232:235]
    v_permlane16_swap_b32_e32 v217, v219
    v_mfma_f32_16x16x32_bf16 v[232:235], a[128:131], v[96:99], v[232:235]
    buffer_store_dwordx4 v[216:219], v247, s[16:19], 0 offen offset:448 sc0 sc1
    v_mfma_f32_16x16x32_bf16 v[236:239], a[128:131], v[160:163], v[236:239]
    s_nop 2
    v_mfma_f32_16x16x32_bf16 v[236:239], a[132:135], v[164:167], v[236:239]
    s_nop 2
    v_mfma_f32_16x16x32_bf16 v[236:239], a[136:139], v[168:171], v[236:239]
    v_mul_f32_e32 v232, v232, v252
    v_mul_f32_e32 v233, v233, v252
    v_mfma_f32_16x16x32_bf16 v[236:239], a[140:143], v[172:175], v[236:239]
    v_mul_f32_e32 v234, v234, v252
    v_mul_f32_e32 v235, v235, v252
    v_mfma_f32_16x16x32_bf16 v[236:239], a[144:147], v[176:179], v[236:239]
    v_cvt_pk_bf16_f32 v222, v232, v233
    v_cvt_pk_bf16_f32 v223, v234, v235
    v_mfma_f32_16x16x32_bf16 v[236:239], a[148:151], v[180:183], v[236:239]
    v_mfma_f32_16x16x32_bf16 v[236:239], a[152:155], v[184:187], v[236:239]
    v_permlane16_swap_b32_e32 v220, v222
    v_mfma_f32_16x16x32_bf16 v[236:239], a[156:159], v[188:191], v[236:239]
    v_permlane16_swap_b32_e32 v221, v223
    s_nop 7
    buffer_store_dwordx4 v[220:223], v247, s[16:19], s45 offen offset:448 sc0 sc1
    v_mul_f32_e32 v236, v236, v253
    v_mul_f32_e32 v237, v237, v253
    v_mul_f32_e32 v238, v238, v253
    v_mul_f32_e32 v239, v239, v253
    v_cvt_pk_bf16_f32 v226, v236, v237
    v_cvt_pk_bf16_f32 v227, v238, v239
    s_nop 0
    v_permlane16_swap_b32_e32 v224, v226
    v_permlane16_swap_b32_e32 v225, v227
    buffer_store_dwordx4 v[224:227], v247, s[20:23], 0 offen offset:448 sc0 sc1
    v_mov_b32_e32 v254, 32768
L_pad7:
    s_cbranch_vccnz L_back
    ds_read_b128 v[0:3], v254
    s_waitcnt lgkmcnt(0)
    v_or3_b32 v0, v0, v1, v2
    v_or_b32_e32 v0, v0, v3
    s_nop 0
    v_readfirstlane_b32 s3, v0
    s_andn2_b32 s3, s3, s34
    s_cbranch_scc1 L_fallback
L_done:
L_exit:
    s_endpgm
L_fallback:
    s_mov_b32 s34, -1
    s_lshl_b32 s3, s36, 18
    s_add_u32 s64, s54, s3
    s_addc_u32 s65, s55, 0
    s_mov_b32 s66, 262144
    s_mov_b32 s67, 0x20000
    v_mbcnt_lo_u32_b32 v8, -1, 0
    v_mbcnt_hi_u32_b32 v8, -1, v8
    v_and_b32_e32 v9, 15, v8
    v_lshrrev_b32_e32 v8, 4, v8
    v_lshlrev_b32_e32 v8, 4, v8
    v_lshl_add_u32 v8, v9, 9, v8
    v_mov_b32_e32 v4, 0xff800000
    v_mov_b32_e32 v5, 0xff800000
    v_mov_b32_e32 v6, 0xff800000
    s_mov_b32 s3, 0
L_fb:
    buffer_load_dwordx4 v[16:19], v8, s[64:67], 0 offen offset:0
    buffer_load_dwordx4 v[20:23], v8, s[64:67], 0 offen offset:64
    buffer_load_dwordx4 v[24:27], v8, s[64:67], 0 offen offset:128
    buffer_load_dwordx4 v[28:31], v8, s[64:67], 0 offen offset:192
    buffer_load_dwordx4 v[32:35], v8, s[64:67], 0 offen offset:256
    buffer_load_dwordx4 v[36:39], v8, s[64:67], 0 offen offset:320
    buffer_load_dwordx4 v[40:43], v8, s[64:67], 0 offen offset:384
    buffer_load_dwordx4 v[44:47], v8, s[64:67], 0 offen offset:448
    v_add_u32_e32 v8, 0x2000, v8
    s_waitcnt vmcnt(0)
    v_mfma_f32_16x16x32_bf16 v[48:51], v[16:19], a[0:3], 0
    v_mfma_f32_16x16x32_bf16 v[48:51], v[20:23], a[4:7], v[48:51]
    v_mfma_f32_16x16x32_bf16 v[48:51], v[24:27], a[8:11], v[48:51]
    v_mfma_f32_16x16x32_bf16 v[48:51], v[28:31], a[12:15], v[48:51]
    v_mfma_f32_16x16x32_bf16 v[48:51], v[32:35], a[16:19], v[48:51]
    v_mfma_f32_16x16x32_bf16 v[48:51], v[36:39], a[20:23], v[48:51]
    v_mfma_f32_16x16x32_bf16 v[48:51], v[40:43], a[24:27], v[48:51]
    v_mfma_f32_16x16x32_bf16 v[48:51], v[44:47], a[28:31], v[48:51]
    v_mfma_f32_16x16x32_bf16 v[52:55], v[16:19], a[32:35], 0
    v_mfma_f32_16x16x32_bf16 v[52:55], v[20:23], a[36:39], v[52:55]
    v_mfma_f32_16x16x32_bf16 v[52:55], v[24:27], a[40:43], v[52:55]
    v_mfma_f32_16x16x32_bf16 v[52:55], v[28:31], a[44:47], v[52:55]
    v_mfma_f32_16x16x32_bf16 v[52:55], v[32:35], a[48:51], v[52:55]
    v_mfma_f32_16x16x32_bf16 v[52:55], v[36:39], a[52:55], v[52:55]
    v_mfma_f32_16x16x32_bf16 v[52:55], v[40:43], a[56:59], v[52:55]
    v_mfma_f32_16x16x32_bf16 v[52:55], v[44:47], a[60:63], v[52:55]
    v_mfma_f32_16x16x32_bf16 v[56:59], v[16:19], a[64:67], 0
    v_mfma_f32_16x16x32_bf16 v[56:59], v[20:23], a[68:71], v[56:59]
    v_mfma_f32_16x16x32_bf16 v[56:59], v[24:27], a[72:75], v[56:59]
    v_mfma_f32_16x16x32_bf16 v[56:59], v[28:31], a[76:79], v[56:59]
    v_mfma_f32_16x16x32_bf16 v[56:59], v[32:35], a[80:83], v[56:59]
    v_mfma_f32_16x16x32_bf16 v[56:59], v[36:39], a[84:87], v[56:59]
    v_mfma_f32_16x16x32_bf16 v[56:59], v[40:43], a[88:91], v[56:59]
    v_mfma_f32_16x16x32_bf16 v[56:59], v[44:47], a[92:95], v[56:59]
    s_nop 7
    v_max3_f32 v4, v4, v48, v49
    v_max3_f32 v4, v4, v50, v51
    v_max3_f32 v5, v5, v52, v53
    v_max3_f32 v5, v5, v54, v55
    v_max3_f32 v6, v6, v56, v57
    v_max3_f32 v6, v6, v58, v59
    s_add_u32 s3, s3, 1
    s_cmp_lt_u32 s3, 32
    s_cbranch_scc1 L_fb
    v_mov_b32_e32 v248, 0x7f800000
    v_mov_b32_e32 v7, v4
    s_nop 1
    v_permlane32_swap_b32_e32 v4, v7
    v_max_f32_e32 v4, v4, v7
    v_mov_b32_e32 v7, v4
    s_nop 1
    v_permlane16_swap_b32_e32 v4, v7
    v_max_f32_e32 v4, v4, v7
    v_min_f32_e64 v248, v248, -v4
    v_mov_b32_e32 v249, 0x7f800000
    v_mov_b32_e32 v7, v5
    s_nop 1
    v_permlane32_swap_b32_e32 v5, v7
    v_max_f32_e32 v5, v5, v7
    v_mov_b32_e32 v7, v5
    s_nop 1
    v_permlane16_swap_b32_e32 v5, v7
    v_max_f32_e32 v5, v5, v7
    v_min_f32_e64 v249, v249, -v5
    v_mov_b32_e32 v250, 0x7f800000
    v_mov_b32_e32 v7, v6
    s_nop 1
    v_permlane32_swap_b32_e32 v6, v7
    v_max_f32_e32 v6, v6, v7
    v_mov_b32_e32 v7, v6
    s_nop 1
    v_permlane16_swap_b32_e32 v6, v7
    v_max_f32_e32 v6, v6, v7
    v_min_f32_e64 v250, v250, -v6
    s_barrier
    s_branch L_start
L_last:
    s_endpgm
.section .rodata,"a"
.p2align 6
.amdhsa_kernel standalone__mha_softmax__near_ridge_kernel
  .amdhsa_next_free_vgpr 512
  .amdhsa_next_free_sgpr 102
  .amdhsa_accum_offset 256
  .amdhsa_group_segment_fixed_size 0
  .amdhsa_kernarg_size 48
  .amdhsa_user_sgpr_count 2
  .amdhsa_user_sgpr_kernarg_segment_ptr 1
  .amdhsa_system_sgpr_workgroup_id_x 1
.end_amdhsa_kernel
```
